```python
import torch

def _softmax(x, axis=-1):
    return torch.softmax(x, dim=axis)
def _gelu(x):
    return torch.nn.functional.gelu(x, approximate="tanh")
def _silu(x):
    return torch.nn.functional.silu(x)
def _sigmoid(x):
    return torch.sigmoid(x)
def _layernorm(x, axis=-1, eps=1e-5):
    m = x.mean(dim=axis, keepdim=True)
    v = x.var(dim=axis, keepdim=True, unbiased=False)
    return (x - m) / torch.sqrt(v + eps)
def _scatter_add(tgt, idx, src, axis=0):
    return tgt.clone().index_add_(axis, idx, src)
def _segment_sum(src, seg, n):
    out = torch.zeros((n,) + src.shape[1:], dtype=src.dtype)
    return out.index_add_(0, seg, src)
def _pad(x, pw):
    flat = tuple(v for pair in reversed(pw) for v in pair)
    return torch.nn.functional.pad(x, flat)

kernel_name = 'parallel_sum__mha_block_cached__dense_activation_silu__decode'

def setup_inputs():

    _w = (lambda a: (lambda t: t.to(torch.bfloat16) if t.is_floating_point() else t)(torch.as_tensor(a)))
    def _A_setup():
        B, Sq, D = 2, 1, 640
        H, Sk, Dh = 32, 4096, 128
        return {
            "x": _w((lambda *s: torch.randn(*s, dtype=torch.bfloat16) * 0.05)(B, Sq, D)),
            "k_cache": _w((lambda *s: torch.randn(*s, dtype=torch.bfloat16) * 3.2)(B, H, Sk, Dh)),
            "v_cache": _w((lambda *s: torch.randn(*s, dtype=torch.bfloat16) * 0.8)(B, H, Sk, Dh)),
            "wq": _w((lambda *s: torch.randn(*s, dtype=torch.bfloat16) * 3.2)(D, H * Dh) * (D ** -0.5)),
            "wo": _w((lambda *s: torch.randn(*s, dtype=torch.bfloat16) * 0.8)(H * Dh, D) * ((H * Dh) ** -0.5)),
        }
    _A_in = _A_setup()

    def _B_setup():
        B, S, D, F = 2, 1, 640, 1728
        return {
            "x": _w((lambda *s: torch.randn(*s, dtype=torch.bfloat16) * 0.05)(B, S, D)),
            "w1": _w((lambda *s: torch.randn(*s, dtype=torch.bfloat16) * 3.2)(D, F) * (D ** -0.5)),
            "w2": _w((lambda *s: torch.randn(*s, dtype=torch.bfloat16) * 0.4)(F, D) * (F ** -0.5)),
        }
    _B_in = _B_setup()

    return {
        "A_x": _A_in["x"],
        "A_k_cache": _A_in["k_cache"],
        "A_v_cache": _A_in["v_cache"],
        "A_wq": _A_in["wq"],
        "A_wo": _A_in["wo"],
        "B_x": _B_in["x"],
        "B_w1": _B_in["w1"],
        "B_w2": _B_in["w2"],
    }

def reference(A_x, A_k_cache, A_v_cache, A_wq, A_wo, B_x, B_w1, B_w2):
    def _A_ref(x, k_cache, v_cache, wq, wo):
        B, Sq, D = x.shape
        H, Dh = 32, 128
        q = (lambda x, *d: x.permute(*d))((x @ wq).reshape(B, Sq, H, Dh), 0, 2, 1, 3)
        scores = torch.einsum("bhqd,bhkd->bhqk", q, k_cache) * (Dh ** -0.5)
        p = _softmax(scores, axis=-1)
        o = torch.einsum("bhqk,bhkd->bhqd", p, v_cache)
        return (lambda x, *d: x.permute(*d))(o, 0, 2, 1, 3).reshape(B, Sq, H * Dh) @ wo

    def _B_ref(x, w1, w2):
        h = torch.einsum("bsd,df->bsf", x, w1)
        h = _silu(h)
        out = torch.einsum("bsf,fd->bsd", h, w2)
        return out

    x = A_x
    xn = _layernorm(x, axis=-1)
    return x + _A_ref(xn, A_k_cache, A_v_cache, A_wq, A_wo) + _B_ref(xn, B_w1, B_w2)
```

```asm
; @launch grid=(256,1,1) block=(1024,1,1) lds=152832
.amdgcn_target "amdgcn-amd-amdhsa--gfx950"
.text
.globl parallel_sum__mha_block_cached__dense_activation_silu__decode_kernel
.p2align 8
.type parallel_sum__mha_block_cached__dense_activation_silu__decode_kernel,@function
parallel_sum__mha_block_cached__dense_activation_silu__decode_kernel:
  s_cmp_ge_u32 s2, 256
  s_cbranch_scc1 L_end
  s_load_dwordx16 s[4:19], s[0:1], 0
  s_load_dwordx4 s[20:23], s[0:1], 64
  s_load_dwordx2 s[24:25], s[0:1], 80
  v_lshrrev_b32 v2, 6, v0
  v_and_b32 v0, 63, v0
  v_readfirstlane_b32 s26, v2
  s_and_b32 s56, s2, 7
  s_lshr_b32 s57, s2, 3
  s_lshr_b32 s59, s57, 3
  s_lshl_b32 s52, s59, 3
  s_add_u32 s52, s52, s56
  s_and_b32 s55, s57, 7
  s_and_b32 s58, s2, 7
  s_lshl_b32 s58, s58, 2
  s_bfe_u32 s59, s2, 0x20006
  s_add_u32 s58, s58, s59
  s_mov_b32 s56, 0xf030f0f
  s_lshl_b32 s57, 1, s58
  s_sub_u32 s59, s57, 1
  s_and_b32 s59, s59, s56
  s_bcnt1_i32_b32 s3, s59
  s_lshl_b32 s3, s3, 1
  s_sub_u32 s58, s26, 2
  s_add_u32 s3, s3, s58
  s_and_b32 s57, s57, s56
  s_cselect_b32 s3, s3, 31
  s_cmp_lt_u32 s58, 2
  s_cselect_b32 s3, s3, 31
  s_min_u32 s3, s3, 31
  s_and_b32 s53, s26, 1
  s_lshr_b32 s54, s26, 1
  s_mov_b32 s60, 0x05040100
  s_mov_b32 s61, 0x07060302
  s_mov_b32 s62, 0x3db504f3
  s_mov_b32 s63, 0x3fb8aa3b
  s_mov_b32 s67, 0xffff0000
  s_movk_i32 s76, 0x1000
  s_movk_i32 s77, 0x2000
  s_movk_i32 s78, 0x3000
  s_min_u32 s79, s3, 26
  s_lshl_b32 s59, s52, 8
  s_lshl_b32 s57, s53, 7
  s_add_u32 s59, s59, s57
  s_lshl_b32 s57, s79, 7
  s_movk_i32 s65, 0x2000
  s_cmp_ge_u32 s26, 2
  s_cselect_b32 s65, 3456, s65
  s_cselect_b32 s59, s57, s59
  s_mul_i32 s58, s55, 80
  s_mul_i32 s58, s58, s65
  s_add_u32 s71, s58, s59
  s_bfe_u32 s56, s26, 0x10002
  s_lshr_b32 s58, s26, 3
  s_lshl_b32 s58, s58, 2
  s_and_b32 s57, s26, 3
  s_or_b32 s58, s58, s57
  s_lshl_b32 s56, s56, 5
  s_add_u32 s56, s56, s52
  s_lshl_b32 s56, s56, 20
  s_bfe_u32 s58, s26, 0x10000
  s_lshl_b32 s58, s58, 15
  s_bfe_u32 s57, s26, 0x10001
  s_lshl_b32 s57, s57, 16
  s_or_b32 s58, s58, s57
  s_bfe_u32 s57, s26, 0x10003
  s_lshl_b32 s57, s57, 17
  s_or_b32 s58, s58, s57
  s_bfe_u32 s57, s55, 0x10000
  s_lshl_b32 s57, s57, 12
  s_or_b32 s58, s58, s57
  s_bfe_u32 s57, s55, 0x10001
  s_lshl_b32 s57, s57, 18
  s_or_b32 s58, s58, s57
  s_bfe_u32 s57, s55, 0x10002
  s_lshl_b32 s57, s57, 19
  s_or_b32 s58, s58, s57
  v_and_b32 v1, 15, v0
  v_lshlrev_b32 v1, 4, v1
  v_bfe_u32 v2, v0, 4, 1
  v_lshl_or_b32 v1, v2, 8, v1
  v_bfe_u32 v2, v0, 5, 1
  v_lshl_or_b32 v1, v2, 9, v1
  v_or_b32 v1, s58, v1
  v_mov_b32 v2, 54400
  v_mov_b32 v8, 0
  v_mov_b32 v9, 0
  v_mov_b32 v10, 0
  v_mov_b32 v11, 0
  ds_write_b128 v2, v[8:11]
  ds_write_b128 v2, v[8:11] offset:16
  v_mul_u32_u24 v7, 20, v0
  v_lshrrev_b32 v3, 3, v0
  v_and_b32 v4, 7, v0
  v_lshlrev_b32 v4, 4, v4
  s_mul_i32 s57, s65, 10
  v_mul_u32_u24 v14, s57, v3
  v_add_u32 v14, v14, v4
  s_waitcnt lgkmcnt(0)
  s_load_dword s27, s[24:25], 0
  s_cmp_ge_u32 s26, 2
  s_cselect_b32 s40, s16, s10
  s_cselect_b32 s41, s17, s11
  s_add_u32 s40, s40, s71
  s_addc_u32 s41, s41, 0
  s_mul_i32 s42, s65, 79
  s_add_u32 s42, s42, 128
  s_mov_b32 s43, 0x20000
  s_mov_b32 s44, s4
  s_mov_b32 s45, s5
  s_movk_i32 s46, 2560
  s_mov_b32 s47, 0x20000
  s_add_u32 s28, s6, s56
  s_addc_u32 s29, s7, 0
  s_mov_b32 s30, 0x100000
  s_mov_b32 s31, 0x20000
  s_add_u32 s32, s8, s56
  s_addc_u32 s33, s9, 0
  s_mov_b32 s34, 0x100000
  s_mov_b32 s35, 0x20000
  s_cmp_lt_u32 s26, 2
  s_cbranch_scc1 L_pw_x
  s_cmp_lt_u32 s3, 27
  s_cbranch_scc1 L_pw_w
  s_branch L_initbar
L_pw_x:
  s_nop 4
  s_mul_i32 s57, s26, 1280
  buffer_load_dwordx4 v[2:5], v7, s[44:47], s57 offen
  buffer_load_dword v6, v7, s[44:47], s57 offen offset:16
L_pw_w:
  s_nop 4
  s_mov_b32 s57, 0
  buffer_load_dwordx4 v[80:83], v14, s[40:43], s57 offen nt
  s_add_u32 s57, s57, s65
  buffer_load_dwordx4 v[84:87], v14, s[40:43], s57 offen nt
  s_add_u32 s57, s57, s65
  buffer_load_dwordx4 v[88:91], v14, s[40:43], s57 offen nt
  s_add_u32 s57, s57, s65
  buffer_load_dwordx4 v[92:95], v14, s[40:43], s57 offen nt
  s_add_u32 s57, s57, s65
  buffer_load_dwordx4 v[96:99], v14, s[40:43], s57 offen nt
  s_add_u32 s57, s57, s65
  buffer_load_dwordx4 v[100:103], v14, s[40:43], s57 offen nt
  s_add_u32 s57, s57, s65
  buffer_load_dwordx4 v[104:107], v14, s[40:43], s57 offen nt
  s_add_u32 s57, s57, s65
  buffer_load_dwordx4 v[108:111], v14, s[40:43], s57 offen nt
  s_add_u32 s57, s57, s65
  buffer_load_dwordx4 v[112:115], v14, s[40:43], s57 offen nt
  s_add_u32 s57, s57, s65
  buffer_load_dwordx4 v[116:119], v14, s[40:43], s57 offen nt
L_initbar:
  s_nop 4
  s_cmp_lt_u32 s26, 3
  s_cbranch_scc1 L_doearly
  s_cmp_lt_u32 s3, 27
  s_cbranch_scc0 L_noearly
L_doearly:
  s_nop 4
  buffer_load_dwordx4 v[16:19], v1, s[28:31], 0 offen offset:0 nt
  buffer_load_dwordx4 v[20:23], v1, s[28:31], 0 offen offset:1024 nt
  buffer_load_dwordx4 v[24:27], v1, s[28:31], 0 offen offset:2048 nt
  buffer_load_dwordx4 v[28:31], v1, s[28:31], 0 offen offset:3072 nt
  s_mov_b32 s57, 0x2000
  buffer_load_dwordx4 v[32:35], v1, s[28:31], s57 offen offset:0 nt
  s_mov_b32 s57, 0x2000
  buffer_load_dwordx4 v[36:39], v1, s[28:31], s57 offen offset:1024 nt
  s_mov_b32 s57, 0x2000
  buffer_load_dwordx4 v[40:43], v1, s[28:31], s57 offen offset:2048 nt
  s_mov_b32 s57, 0x2000
  buffer_load_dwordx4 v[44:47], v1, s[28:31], s57 offen offset:3072 nt
  s_mov_b32 s57, 0x4000
  buffer_load_dwordx4 v[48:51], v1, s[28:31], s57 offen offset:0 nt
  s_mov_b32 s57, 0x4000
  buffer_load_dwordx4 v[52:55], v1, s[28:31], s57 offen offset:1024 nt
  s_mov_b32 s57, 0x4000
  buffer_load_dwordx4 v[56:59], v1, s[28:31], s57 offen offset:2048 nt
  s_mov_b32 s57, 0x4000
  buffer_load_dwordx4 v[60:63], v1, s[28:31], s57 offen offset:3072 nt
  s_mov_b32 s57, 0x6000
  buffer_load_dwordx4 v[64:67], v1, s[28:31], s57 offen offset:0 nt
  s_mov_b32 s57, 0x6000
  buffer_load_dwordx4 v[68:71], v1, s[28:31], s57 offen offset:1024 nt
  s_mov_b32 s57, 0x6000
  buffer_load_dwordx4 v[72:75], v1, s[28:31], s57 offen offset:2048 nt
  s_mov_b32 s57, 0x6000
  buffer_load_dwordx4 v[76:79], v1, s[28:31], s57 offen offset:3072 nt
L_noearly:
  s_nop 4
  s_mov_b32 s36, s24
  s_mov_b32 s37, s25
  s_mov_b32 s38, 4194304
  s_mov_b32 s39, 0x20000
  s_mov_b32 s48, s20
  s_mov_b32 s49, s21
  s_movk_i32 s50, 2560
  s_mov_b32 s51, 0x20000
  s_mul_i32 s56, s52, 163840
  s_mul_i32 s57, s55, 160
  s_add_u32 s56, s56, s57
  s_add_u32 s80, s12, s56
  s_addc_u32 s81, s13, 0
  s_mov_b32 s82, 162720
  s_mov_b32 s83, 0x20000
  s_getreg_b32 s15, hwreg(HW_REG_XCC_ID, 0, 4)
  s_bfe_u32 s72, s26, 0x10002
  s_lshr_b32 s73, s26, 3
  s_lshl_b32 s73, s73, 2
  s_and_b32 s57, s26, 3
  s_or_b32 s73, s73, s57
  s_lshl_b32 s73, s73, 1
  s_add_u32 s73, s73, s72
  s_barrier
  s_cmp_lt_u32 s26, 2
  s_cbranch_scc1 L_p
  s_cmp_lt_u32 s3, 27
  s_cbranch_scc1 L_p
L_notp:
  s_nop 4
  s_cmp_lt_u32 s26, 3
  s_cbranch_scc1 L_nok
  buffer_load_dwordx4 v[16:19], v1, s[28:31], 0 offen offset:0 nt
  buffer_load_dwordx4 v[20:23], v1, s[28:31], 0 offen offset:1024 nt
  buffer_load_dwordx4 v[24:27], v1, s[28:31], 0 offen offset:2048 nt
  buffer_load_dwordx4 v[28:31], v1, s[28:31], 0 offen offset:3072 nt
  s_mov_b32 s57, 0x2000
  buffer_load_dwordx4 v[32:35], v1, s[28:31], s57 offen offset:0 nt
  s_mov_b32 s57, 0x2000
  buffer_load_dwordx4 v[36:39], v1, s[28:31], s57 offen offset:1024 nt
  s_mov_b32 s57, 0x2000
  buffer_load_dwordx4 v[40:43], v1, s[28:31], s57 offen offset:2048 nt
  s_mov_b32 s57, 0x2000
  buffer_load_dwordx4 v[44:47], v1, s[28:31], s57 offen offset:3072 nt
  s_mov_b32 s57, 0x4000
  buffer_load_dwordx4 v[48:51], v1, s[28:31], s57 offen offset:0 nt
  s_mov_b32 s57, 0x4000
  buffer_load_dwordx4 v[52:55], v1, s[28:31], s57 offen offset:1024 nt
  s_mov_b32 s57, 0x4000
  buffer_load_dwordx4 v[56:59], v1, s[28:31], s57 offen offset:2048 nt
  s_mov_b32 s57, 0x4000
  buffer_load_dwordx4 v[60:63], v1, s[28:31], s57 offen offset:3072 nt
  s_mov_b32 s57, 0x6000
  buffer_load_dwordx4 v[64:67], v1, s[28:31], s57 offen offset:0 nt
  s_mov_b32 s57, 0x6000
  buffer_load_dwordx4 v[68:71], v1, s[28:31], s57 offen offset:1024 nt
  s_mov_b32 s57, 0x6000
  buffer_load_dwordx4 v[72:75], v1, s[28:31], s57 offen offset:2048 nt
  s_mov_b32 s57, 0x6000
  buffer_load_dwordx4 v[76:79], v1, s[28:31], s57 offen offset:3072 nt
L_nok:
  s_nop 4
  s_cmp_ge_u32 s26, 8
  s_cbranch_scc1 L_late0
  s_sub_u32 s56, s26, 4
  s_cmp_lt_u32 s56, 4
  s_cbranch_scc0 L_nog
  s_bfe_u32 s66, s26, 0x10001
  s_lshl_b32 s68, s52, 14
  s_lshl_b32 s56, s66, 10
  s_add_u32 s68, s68, s56
  s_lshl_b32 s56, s53, 9
  s_add_u32 s68, s68, s56
  s_add_u32 s68, s68, 720896
  s_add_u32 s69, s68, 0x1000
  s_add_u32 s70, s68, 0x2000
  s_add_u32 s71, s68, 0x3000
  v_lshlrev_b32 v3, 3, v0
  s_mov_b32 s64, 0
  s_mul_i32 s58, s26, 6144
  s_add_u32 s58, s58, 54528
  s_add_u32 m0, s58, 0
  s_mov_b32 s57, 0x0
  buffer_load_dwordx4 v1, s[32:35], s57 offen nt lds
  s_add_u32 m0, s58, 1024
  s_mov_b32 s57, 0x2000
  buffer_load_dwordx4 v1, s[32:35], s57 offen nt lds
  s_add_u32 m0, s58, 2048
  s_mov_b32 s57, 0x800
  buffer_load_dwordx4 v1, s[32:35], s57 offen nt lds
  s_add_u32 m0, s58, 3072
  s_mov_b32 s57, 0x2800
  buffer_load_dwordx4 v1, s[32:35], s57 offen nt lds
  s_add_u32 m0, s58, 4096
  s_mov_b32 s57, 0x400
  buffer_load_dwordx4 v1, s[32:35], s57 offen nt lds
  s_add_u32 m0, s58, 5120
  s_mov_b32 s57, 0x2400
  buffer_load_dwordx4 v1, s[32:35], s57 offen nt lds
  buffer_load_dwordx4 v[80:83], v1, s[32:35], 0 offen offset:3072 nt
  s_mov_b32 s57, 0x2000
  buffer_load_dwordx4 v[84:87], v1, s[32:35], s57 offen offset:3072 nt
  s_mov_b32 s57, 0x4000
  buffer_load_dwordx4 v[88:91], v1, s[32:35], s57 offen offset:0 nt
  s_mov_b32 s57, 0x6000
  buffer_load_dwordx4 v[92:95], v1, s[32:35], s57 offen offset:0 nt
  s_mov_b32 s57, 0x4000
  buffer_load_dwordx4 v[96:99], v1, s[32:35], s57 offen offset:2048 nt
  s_mov_b32 s57, 0x6000
  buffer_load_dwordx4 v[100:103], v1, s[32:35], s57 offen offset:2048 nt
  s_mov_b32 s57, 0x4000
  buffer_load_dwordx4 v[104:107], v1, s[32:35], s57 offen offset:1024 nt
  s_mov_b32 s57, 0x6000
  buffer_load_dwordx4 v[108:111], v1, s[32:35], s57 offen offset:1024 nt
  s_mov_b32 s57, 0x4000
  buffer_load_dwordx4 v[112:115], v1, s[32:35], s57 offen offset:3072 nt
  s_mov_b32 s57, 0x6000
  buffer_load_dwordx4 v[116:119], v1, s[32:35], s57 offen offset:3072 nt
  s_waitcnt lgkmcnt(0)
  s_and_b32 s27, s27, 0xfffffff0
  s_add_u32 s27, s27, 16
  s_or_b32 s14, s27, s15
  s_add_u32 s22, s27, 15
  s_setprio 3
L_qpoll:
  s_nop 4
  buffer_load_dwordx2 v[8:9], v3, s[36:39], s68 offen offset:0 sc1
  buffer_load_dwordx2 v[10:11], v3, s[36:39], s68 offen offset:2048 sc1
  buffer_load_dwordx2 v[12:13], v3, s[36:39], s69 offen offset:0 sc1
  buffer_load_dwordx2 v[14:15], v3, s[36:39], s69 offen offset:2048 sc1
  buffer_load_dwordx2 v[120:121], v3, s[36:39], s70 offen offset:0 sc1
  buffer_load_dwordx2 v[122:123], v3, s[36:39], s70 offen offset:2048 sc1
  buffer_load_dwordx2 v[124:125], v3, s[36:39], s71 offen offset:0 sc1
  buffer_load_dwordx2 v[126:127], v3, s[36:39], s71 offen offset:2048 sc1
  s_waitcnt vmcnt(0)
  v_min3_u32 v4, v9, v11, v13
  v_min3_u32 v4, v4, v15, v121
  v_min3_u32 v4, v4, v123, v125
  v_min3_u32 v4, v4, v127, v127
  v_max3_u32 v5, v9, v11, v13
  v_max3_u32 v5, v5, v15, v121
  v_max3_u32 v5, v5, v123, v125
  v_max3_u32 v5, v5, v127, v127
  v_cmp_gt_u32 vcc, s27, v4
  v_cmp_lt_u32 s[58:59], s22, v5
  s_nop 0
  s_or_b64 s[58:59], vcc, s[58:59]
  s_cbranch_scc0 L_qpoll_ok
  s_add_u32 s64, s64, 1
  s_cmp_lt_u32 s64, 1048576
  s_cbranch_scc1 L_qpoll
L_qpoll_ok:
  s_nop 4
  s_setprio 0
  v_cmp_ne_u32 vcc, s14, v4
  v_cmp_ne_u32 s[58:59], s14, v5
  v_add_f32 v8, v8, v10
  v_add_f32 v12, v12, v14
  v_add_f32 v120, v120, v122
  v_add_f32 v124, v124, v126
  s_or_b64 s[58:59], vcc, s[58:59]
  s_cselect_b32 s57, 0x101, 1
  v_add_f32 v8, v8, v12
  v_add_f32 v120, v120, v124
  v_add_f32 v8, v8, v120
  v_cvt_pk_bf16_f32 v8, v8, v8
  v_lshlrev_b32 v3, 1, v0
  s_lshl_b32 s56, s66, 8
  s_lshl_b32 s58, s53, 7
  s_add_u32 s56, s56, s58
  v_add_u32 v3, s56, v3
  ds_write_b16 v3, v8 offset:52736
  v_mov_b32 v3, 54400
  v_mov_b32 v4, s57
  s_mov_b64 exec, 1
  ds_add_u32 v3, v4 offset:4
  s_mov_b64 exec, -1
  s_branch L_qw
L_nog:
  s_nop 4
  s_mul_i32 s58, s26, 6144
  s_add_u32 s58, s58, 54528
  s_add_u32 m0, s58, 0
  s_mov_b32 s57, 0x0
  buffer_load_dwordx4 v1, s[32:35], s57 offen nt lds
  s_add_u32 m0, s58, 1024
  s_mov_b32 s57, 0x2000
  buffer_load_dwordx4 v1, s[32:35], s57 offen nt lds
  s_add_u32 m0, s58, 2048
  s_mov_b32 s57, 0x800
  buffer_load_dwordx4 v1, s[32:35], s57 offen nt lds
  s_add_u32 m0, s58, 3072
  s_mov_b32 s57, 0x2800
  buffer_load_dwordx4 v1, s[32:35], s57 offen nt lds
  s_add_u32 m0, s58, 4096
  s_mov_b32 s57, 0x400
  buffer_load_dwordx4 v1, s[32:35], s57 offen nt lds
  s_add_u32 m0, s58, 5120
  s_mov_b32 s57, 0x2400
  buffer_load_dwordx4 v1, s[32:35], s57 offen nt lds
  buffer_load_dwordx4 v[80:83], v1, s[32:35], 0 offen offset:3072 nt
  s_mov_b32 s57, 0x2000
  buffer_load_dwordx4 v[84:87], v1, s[32:35], s57 offen offset:3072 nt
  s_mov_b32 s57, 0x4000
  buffer_load_dwordx4 v[88:91], v1, s[32:35], s57 offen offset:0 nt
  s_mov_b32 s57, 0x6000
  buffer_load_dwordx4 v[92:95], v1, s[32:35], s57 offen offset:0 nt
  s_mov_b32 s57, 0x4000
  buffer_load_dwordx4 v[96:99], v1, s[32:35], s57 offen offset:2048 nt
  s_mov_b32 s57, 0x6000
  buffer_load_dwordx4 v[100:103], v1, s[32:35], s57 offen offset:2048 nt
  s_mov_b32 s57, 0x4000
  buffer_load_dwordx4 v[104:107], v1, s[32:35], s57 offen offset:1024 nt
  s_mov_b32 s57, 0x6000
  buffer_load_dwordx4 v[108:111], v1, s[32:35], s57 offen offset:1024 nt
  s_mov_b32 s57, 0x4000
  buffer_load_dwordx4 v[112:115], v1, s[32:35], s57 offen offset:3072 nt
  s_mov_b32 s57, 0x6000
  buffer_load_dwordx4 v[116:119], v1, s[32:35], s57 offen offset:3072 nt
  s_waitcnt lgkmcnt(0)
  s_and_b32 s27, s27, 0xfffffff0
  s_add_u32 s27, s27, 16
  s_or_b32 s14, s27, s15
  s_add_u32 s22, s27, 15
  s_branch L_qw
L_p:
  s_nop 4
  s_setprio 3
  s_cmp_lt_u32 s26, 2
  s_cbranch_scc0 L_noln
  s_waitcnt vmcnt(26)
  s_mov_b32 s56, 0x3f803f80
  v_dot2_f32_bf16 v8, v2, s56, 0
  v_dot2_f32_bf16 v8, v3, s56, v8
  v_dot2_f32_bf16 v8, v4, s56, v8
  v_dot2_f32_bf16 v8, v5, s56, v8
  v_dot2_f32_bf16 v8, v6, s56, v8
  s_nop 2
  v_add_f32_dpp v8, v8, v8 row_ror:8 row_mask:0xf bank_mask:0xf
  s_nop 1
  v_add_f32_dpp v8, v8, v8 row_ror:4 row_mask:0xf bank_mask:0xf
  s_nop 1
  v_add_f32_dpp v8, v8, v8 row_ror:2 row_mask:0xf bank_mask:0xf
  s_nop 1
  v_add_f32_dpp v8, v8, v8 row_ror:1 row_mask:0xf bank_mask:0xf
  v_mov_b32 v9, v8
  s_nop 1
  v_permlane16_swap_b32 v8, v9
  v_add_f32 v8, v8, v9
  v_mov_b32 v9, v8
  s_nop 1
  v_permlane32_swap_b32 v8, v9
  v_add_f32 v8, v8, v9
  v_mul_f32 v8, 0x3acccccd, v8
  v_mov_b32 v10, 0
  v_mov_b32 v11, 0
  v_lshlrev_b32 v12, 16, v2
  v_and_b32 v13, s67, v2
  v_sub_f32 v12, v12, v8
  v_sub_f32 v13, v13, v8
  v_fmac_f32 v10, v12, v12
  v_fmac_f32 v11, v13, v13
  v_lshlrev_b32 v12, 16, v3
  v_and_b32 v13, s67, v3
  v_sub_f32 v12, v12, v8
  v_sub_f32 v13, v13, v8
  v_fmac_f32 v10, v12, v12
  v_fmac_f32 v11, v13, v13
  v_lshlrev_b32 v12, 16, v4
  v_and_b32 v13, s67, v4
  v_sub_f32 v12, v12, v8
  v_sub_f32 v13, v13, v8
  v_fmac_f32 v10, v12, v12
  v_fmac_f32 v11, v13, v13
  v_lshlrev_b32 v12, 16, v5
  v_and_b32 v13, s67, v5
  v_sub_f32 v12, v12, v8
  v_sub_f32 v13, v13, v8
  v_fmac_f32 v10, v12, v12
  v_fmac_f32 v11, v13, v13
  v_lshlrev_b32 v12, 16, v6
  v_and_b32 v13, s67, v6
  v_sub_f32 v12, v12, v8
  v_sub_f32 v13, v13, v8
  v_fmac_f32 v10, v12, v12
  v_fmac_f32 v11, v13, v13
  v_add_f32 v10, v10, v11
  s_nop 1
  v_add_f32_dpp v10, v10, v10 row_ror:8 row_mask:0xf bank_mask:0xf
  s_nop 1
  v_add_f32_dpp v10, v10, v10 row_ror:4 row_mask:0xf bank_mask:0xf
  s_nop 1
  v_add_f32_dpp v10, v10, v10 row_ror:2 row_mask:0xf bank_mask:0xf
  s_nop 1
  v_add_f32_dpp v10, v10, v10 row_ror:1 row_mask:0xf bank_mask:0xf
  v_mov_b32 v9, v10
  s_nop 1
  v_permlane16_swap_b32 v10, v9
  v_add_f32 v10, v10, v9
  v_mov_b32 v9, v10
  s_nop 1
  v_permlane32_swap_b32 v10, v9
  v_add_f32 v10, v10, v9
  v_mul_f32 v10, 0x3acccccd, v10
  v_cvt_pk_bf16_f32 v9, v8, v10
  v_lshlrev_b32 v8, 16, v9
  v_and_b32 v10, s67, v9
  v_add_f32 v10, 0x3727c5ac, v10
  v_cvt_pk_bf16_f32 v10, v10, v10
  v_and_b32 v10, s67, v10
  v_sqrt_f32 v10, v10
  s_nop 0
  v_cvt_pk_bf16_f32 v10, v10, v10
  v_and_b32 v10, s67, v10
  v_rcp_f32 v11, v10
  v_lshlrev_b32 v12, 16, v2
  v_and_b32 v13, s67, v2
  v_sub_f32 v12, v12, v8
  v_sub_f32 v13, v13, v8
  v_cvt_pk_bf16_f32 v120, v12, v13
  v_lshlrev_b32 v12, 16, v120
  v_and_b32 v13, s67, v120
  v_mul_f32 v120, v11, v12
  v_mul_f32 v121, v11, v13
  v_fma_f32 v12, -v120, v10, v12
  v_fma_f32 v13, -v121, v10, v13
  v_fma_f32 v120, v12, v11, v120
  v_fma_f32 v121, v13, v11, v121
  v_cvt_pk_bf16_f32 v2, v120, v121
  v_lshlrev_b32 v12, 16, v3
  v_and_b32 v13, s67, v3
  v_sub_f32 v12, v12, v8
  v_sub_f32 v13, v13, v8
  v_cvt_pk_bf16_f32 v120, v12, v13
  v_lshlrev_b32 v12, 16, v120
  v_and_b32 v13, s67, v120
  v_mul_f32 v120, v11, v12
  v_mul_f32 v121, v11, v13
  v_fma_f32 v12, -v120, v10, v12
  v_fma_f32 v13, -v121, v10, v13
  v_fma_f32 v120, v12, v11, v120
  v_fma_f32 v121, v13, v11, v121
  v_cvt_pk_bf16_f32 v3, v120, v121
  v_lshlrev_b32 v12, 16, v4
  v_and_b32 v13, s67, v4
  v_sub_f32 v12, v12, v8
  v_sub_f32 v13, v13, v8
  v_cvt_pk_bf16_f32 v120, v12, v13
  v_lshlrev_b32 v12, 16, v120
  v_and_b32 v13, s67, v120
  v_mul_f32 v120, v11, v12
  v_mul_f32 v121, v11, v13
  v_fma_f32 v12, -v120, v10, v12
  v_fma_f32 v13, -v121, v10, v13
  v_fma_f32 v120, v12, v11, v120
  v_fma_f32 v121, v13, v11, v121
  v_cvt_pk_bf16_f32 v4, v120, v121
  v_lshlrev_b32 v12, 16, v5
  v_and_b32 v13, s67, v5
  v_sub_f32 v12, v12, v8
  v_sub_f32 v13, v13, v8
  v_cvt_pk_bf16_f32 v120, v12, v13
  v_lshlrev_b32 v12, 16, v120
  v_and_b32 v13, s67, v120
  v_mul_f32 v120, v11, v12
  v_mul_f32 v121, v11, v13
  v_fma_f32 v12, -v120, v10, v12
  v_fma_f32 v13, -v121, v10, v13
  v_fma_f32 v120, v12, v11, v120
  v_fma_f32 v121, v13, v11, v121
  v_cvt_pk_bf16_f32 v5, v120, v121
  v_lshlrev_b32 v12, 16, v6
  v_and_b32 v13, s67, v6
  v_sub_f32 v12, v12, v8
  v_sub_f32 v13, v13, v8
  v_cvt_pk_bf16_f32 v120, v12, v13
  v_lshlrev_b32 v12, 16, v120
  v_and_b32 v13, s67, v120
  v_mul_f32 v120, v11, v12
  v_mul_f32 v121, v11, v13
  v_fma_f32 v12, -v120, v10, v12
  v_fma_f32 v13, -v121, v10, v13
  v_fma_f32 v120, v12, v11, v120
  v_fma_f32 v121, v13, v11, v121
  v_cvt_pk_bf16_f32 v6, v120, v121
  s_mul_i32 s57, s26, 1280
  v_add_u32 v7, s57, v7
  ds_write_b32 v7, v2 offset:50176
  ds_write_b32 v7, v3 offset:50180
  ds_write_b32 v7, v4 offset:50184
  ds_write_b32 v7, v5 offset:50188
  ds_write_b32 v7, v6 offset:50192
  v_mov_b32 v3, 54400
  v_mov_b32 v4, 1
  s_mov_b64 exec, 1
  ds_add_u32 v3, v4
  s_mov_b64 exec, -1
L_noln:
  s_nop 4
  s_waitcnt lgkmcnt(0)
  s_and_b32 s27, s27, 0xfffffff0
  s_add_u32 s27, s27, 16
  s_or_b32 s14, s27, s15
  s_add_u32 s22, s27, 15
  v_mov_b32 v2, 54400
  s_mov_b32 s64, 0
L_xwait:
  s_nop 4
  ds_read_b32 v3, v2 offset:0
  s_waitcnt lgkmcnt(0)
  v_readfirstlane_b32 s56, v3
  s_nop 0
  s_cmp_eq_u32 s56, 2
  s_cbranch_scc1 L_xwait_ok
  s_sleep 2
  s_add_u32 s64, s64, 1
  s_cmp_lt_u32 s64, 1048576
  s_cbranch_scc1 L_xwait
L_xwait_ok:
  s_nop 4
  v_lshrrev_b32 v8, 3, v0
  v_mul_u32_u24 v15, 20, v8
  s_mul_i32 s57, s55, 160
  s_add_u32 s57, s57, 50176
  v_add_u32 v15, s57, v15
  ds_read2_b32 v[2:3], v15 offset0:0 offset1:1
  ds_read2_b32 v[4:5], v15 offset0:2 offset1:3
  ds_read_b32 v6, v15 offset:16
  s_lshl_b32 s56, s52, 3
  s_add_u32 s56, s56, s55
  s_lshl_b32 s56, s56, 11
  s_lshl_b32 s57, s53, 9
  s_add_u32 s56, s56, s57
  s_add_u32 s56, s56, 720896
  s_lshl_b32 s57, s3, 3
  s_add_u32 s57, s57, s55
  s_lshl_b32 s57, s57, 10
  s_add_u32 s57, s57, 1245184
  s_movk_i32 s69, 1024
  s_cmp_ge_u32 s26, 2
  s_cselect_b32 s68, s57, s56
  s_cselect_b32 s69, 512, s69
  s_cselect_b32 s23, s27, s14
  s_waitcnt vmcnt(16)
  s_waitcnt lgkmcnt(0)
  v_perm_b32 v120, v84, v80, s60
  v_perm_b32 v121, v84, v80, s61
  v_perm_b32 v122, v85, v81, s60
  v_perm_b32 v123, v85, v81, s61
  v_perm_b32 v124, v86, v82, s60
  v_perm_b32 v125, v86, v82, s61
  v_perm_b32 v126, v87, v83, s60
  v_perm_b32 v127, v87, v83, s61
  v_dot2_f32_bf16 v7, v2, v120, 0
  v_dot2_f32_bf16 v8, v2, v121, 0
  v_dot2_f32_bf16 v9, v2, v122, 0
  v_dot2_f32_bf16 v10, v2, v123, 0
  v_dot2_f32_bf16 v11, v2, v124, 0
  v_dot2_f32_bf16 v12, v2, v125, 0
  v_dot2_f32_bf16 v13, v2, v126, 0
  v_dot2_f32_bf16 v14, v2, v127, 0
  v_perm_b32 v120, v92, v88, s60
  v_perm_b32 v121, v92, v88, s61
  v_perm_b32 v122, v93, v89, s60
  v_perm_b32 v123, v93, v89, s61
  v_perm_b32 v124, v94, v90, s60
  v_perm_b32 v125, v94, v90, s61
  v_perm_b32 v126, v95, v91, s60
  v_perm_b32 v127, v95, v91, s61
  v_dot2_f32_bf16 v7, v3, v120, v7
  v_dot2_f32_bf16 v8, v3, v121, v8
  v_dot2_f32_bf16 v9, v3, v122, v9
  v_dot2_f32_bf16 v10, v3, v123, v10
  v_dot2_f32_bf16 v11, v3, v124, v11
  v_dot2_f32_bf16 v12, v3, v125, v12
  v_dot2_f32_bf16 v13, v3, v126, v13
  v_dot2_f32_bf16 v14, v3, v127, v14
  v_perm_b32 v120, v100, v96, s60
  v_perm_b32 v121, v100, v96, s61
  v_perm_b32 v122, v101, v97, s60
  v_perm_b32 v123, v101, v97, s61
  v_perm_b32 v124, v102, v98, s60
  v_perm_b32 v125, v102, v98, s61
  v_perm_b32 v126, v103, v99, s60
  v_perm_b32 v127, v103, v99, s61
  v_dot2_f32_bf16 v7, v4, v120, v7
  v_dot2_f32_bf16 v8, v4, v121, v8
  v_dot2_f32_bf16 v9, v4, v122, v9
  v_dot2_f32_bf16 v10, v4, v123, v10
  v_dot2_f32_bf16 v11, v4, v124, v11
  v_dot2_f32_bf16 v12, v4, v125, v12
  v_dot2_f32_bf16 v13, v4, v126, v13
  v_dot2_f32_bf16 v14, v4, v127, v14
  v_perm_b32 v120, v108, v104, s60
  v_perm_b32 v121, v108, v104, s61
  v_perm_b32 v122, v109, v105, s60
  v_perm_b32 v123, v109, v105, s61
  v_perm_b32 v124, v110, v106, s60
  v_perm_b32 v125, v110, v106, s61
  v_perm_b32 v126, v111, v107, s60
  v_perm_b32 v127, v111, v107, s61
  v_dot2_f32_bf16 v7, v5, v120, v7
  v_dot2_f32_bf16 v8, v5, v121, v8
  v_dot2_f32_bf16 v9, v5, v122, v9
  v_dot2_f32_bf16 v10, v5, v123, v10
  v_dot2_f32_bf16 v11, v5, v124, v11
  v_dot2_f32_bf16 v12, v5, v125, v12
  v_dot2_f32_bf16 v13, v5, v126, v13
  v_dot2_f32_bf16 v14, v5, v127, v14
  v_perm_b32 v120, v116, v112, s60
  v_perm_b32 v121, v116, v112, s61
  v_perm_b32 v122, v117, v113, s60
  v_perm_b32 v123, v117, v113, s61
  v_perm_b32 v124, v118, v114, s60
  v_perm_b32 v125, v118, v114, s61
  v_perm_b32 v126, v119, v115, s60
  v_perm_b32 v127, v119, v115, s61
  v_dot2_f32_bf16 v7, v6, v120, v7
  v_dot2_f32_bf16 v8, v6, v121, v8
  v_dot2_f32_bf16 v9, v6, v122, v9
  v_dot2_f32_bf16 v10, v6, v123, v10
  v_dot2_f32_bf16 v11, v6, v124, v11
  v_dot2_f32_bf16 v12, v6, v125, v12
  v_dot2_f32_bf16 v13, v6, v126, v13
  v_dot2_f32_bf16 v14, v6, v127, v14
  v_add_u32 v15, 1280, v15
  ds_read2_b32 v[2:3], v15 offset0:0 offset1:1
  ds_read2_b32 v[4:5], v15 offset0:2 offset1:3
  ds_read_b32 v6, v15 offset:16
  v_permlane32_swap_b32 v7, v11
  v_permlane32_swap_b32 v8, v12
  v_permlane32_swap_b32 v9, v13
  v_permlane32_swap_b32 v10, v14
  v_add_f32 v7, v7, v11
  v_add_f32 v8, v8, v12
  v_add_f32 v9, v9, v13
  v_add_f32 v10, v10, v14
  s_nop 0
  v_permlane16_swap_b32 v7, v9
  v_permlane16_swap_b32 v8, v10
  v_add_f32 v7, v7, v9
  v_add_f32 v8, v8, v10
  s_nop 0
  v_add_f32_dpp v12, v7, v7 row_ror:8 row_mask:0xf bank_mask:0x3
  s_nop 1
  v_add_f32_dpp v12, v8, v8 row_ror:8 row_mask:0xf bank_mask:0xc
  v_mov_b32 v13, s23
  v_and_b32 v10, 7, v0
  v_lshlrev_b32 v10, 6, v10
  v_lshrrev_b32 v11, 3, v0
  v_lshl_add_u32 v10, v11, 3, v10
  buffer_store_dwordx2 v[12:13], v10, s[36:39], s68 offen sc1
  s_add_u32 s68, s68, s69
  s_waitcnt lgkmcnt(0)
  v_perm_b32 v120, v84, v80, s60
  v_perm_b32 v121, v84, v80, s61
  v_perm_b32 v122, v85, v81, s60
  v_perm_b32 v123, v85, v81, s61
  v_perm_b32 v124, v86, v82, s60
  v_perm_b32 v125, v86, v82, s61
  v_perm_b32 v126, v87, v83, s60
  v_perm_b32 v127, v87, v83, s61
  v_dot2_f32_bf16 v7, v2, v120, 0
  v_dot2_f32_bf16 v8, v2, v121, 0
  v_dot2_f32_bf16 v9, v2, v122, 0
  v_dot2_f32_bf16 v10, v2, v123, 0
  v_dot2_f32_bf16 v11, v2, v124, 0
  v_dot2_f32_bf16 v12, v2, v125, 0
  v_dot2_f32_bf16 v13, v2, v126, 0
  v_dot2_f32_bf16 v14, v2, v127, 0
  v_perm_b32 v120, v92, v88, s60
  v_perm_b32 v121, v92, v88, s61
  v_perm_b32 v122, v93, v89, s60
  v_perm_b32 v123, v93, v89, s61
  v_perm_b32 v124, v94, v90, s60
  v_perm_b32 v125, v94, v90, s61
  v_perm_b32 v126, v95, v91, s60
  v_perm_b32 v127, v95, v91, s61
  v_dot2_f32_bf16 v7, v3, v120, v7
  v_dot2_f32_bf16 v8, v3, v121, v8
  v_dot2_f32_bf16 v9, v3, v122, v9
  v_dot2_f32_bf16 v10, v3, v123, v10
  v_dot2_f32_bf16 v11, v3, v124, v11
  v_dot2_f32_bf16 v12, v3, v125, v12
  v_dot2_f32_bf16 v13, v3, v126, v13
  v_dot2_f32_bf16 v14, v3, v127, v14
  v_perm_b32 v120, v100, v96, s60
  v_perm_b32 v121, v100, v96, s61
  v_perm_b32 v122, v101, v97, s60
  v_perm_b32 v123, v101, v97, s61
  v_perm_b32 v124, v102, v98, s60
  v_perm_b32 v125, v102, v98, s61
  v_perm_b32 v126, v103, v99, s60
  v_perm_b32 v127, v103, v99, s61
  v_dot2_f32_bf16 v7, v4, v120, v7
  v_dot2_f32_bf16 v8, v4, v121, v8
  v_dot2_f32_bf16 v9, v4, v122, v9
  v_dot2_f32_bf16 v10, v4, v123, v10
  v_dot2_f32_bf16 v11, v4, v124, v11
  v_dot2_f32_bf16 v12, v4, v125, v12
  v_dot2_f32_bf16 v13, v4, v126, v13
  v_dot2_f32_bf16 v14, v4, v127, v14
  v_perm_b32 v120, v108, v104, s60
  v_perm_b32 v121, v108, v104, s61
  v_perm_b32 v122, v109, v105, s60
  v_perm_b32 v123, v109, v105, s61
  v_perm_b32 v124, v110, v106, s60
  v_perm_b32 v125, v110, v106, s61
  v_perm_b32 v126, v111, v107, s60
  v_perm_b32 v127, v111, v107, s61
  v_dot2_f32_bf16 v7, v5, v120, v7
  v_dot2_f32_bf16 v8, v5, v121, v8
  v_dot2_f32_bf16 v9, v5, v122, v9
  v_dot2_f32_bf16 v10, v5, v123, v10
  v_dot2_f32_bf16 v11, v5, v124, v11
  v_dot2_f32_bf16 v12, v5, v125, v12
  v_dot2_f32_bf16 v13, v5, v126, v13
  v_dot2_f32_bf16 v14, v5, v127, v14
  v_perm_b32 v120, v116, v112, s60
  v_perm_b32 v121, v116, v112, s61
  v_perm_b32 v122, v117, v113, s60
  v_perm_b32 v123, v117, v113, s61
  v_perm_b32 v124, v118, v114, s60
  v_perm_b32 v125, v118, v114, s61
  v_perm_b32 v126, v119, v115, s60
  v_perm_b32 v127, v119, v115, s61
  v_dot2_f32_bf16 v7, v6, v120, v7
  v_dot2_f32_bf16 v8, v6, v121, v8
  v_dot2_f32_bf16 v9, v6, v122, v9
  v_dot2_f32_bf16 v10, v6, v123, v10
  v_dot2_f32_bf16 v11, v6, v124, v11
  v_dot2_f32_bf16 v12, v6, v125, v12
  v_dot2_f32_bf16 v13, v6, v126, v13
  v_dot2_f32_bf16 v14, v6, v127, v14
  v_permlane32_swap_b32 v7, v11
  v_permlane32_swap_b32 v8, v12
  v_permlane32_swap_b32 v9, v13
  v_permlane32_swap_b32 v10, v14
  v_add_f32 v7, v7, v11
  v_add_f32 v8, v8, v12
  v_add_f32 v9, v9, v13
  v_add_f32 v10, v10, v14
  s_nop 0
  v_permlane16_swap_b32 v7, v9
  v_permlane16_swap_b32 v8, v10
  v_add_f32 v7, v7, v9
  v_add_f32 v8, v8, v10
  s_nop 0
  v_add_f32_dpp v12, v7, v7 row_ror:8 row_mask:0xf bank_mask:0x3
  s_nop 1
  v_add_f32_dpp v12, v8, v8 row_ror:8 row_mask:0xf bank_mask:0xc
  v_mov_b32 v13, s23
  v_and_b32 v10, 7, v0
  v_lshlrev_b32 v10, 6, v10
  v_lshrrev_b32 v11, 3, v0
  v_lshl_add_u32 v10, v11, 3, v10
  buffer_store_dwordx2 v[12:13], v10, s[36:39], s68 offen sc1
  s_setprio 0
  s_cmp_ge_u32 s26, 2
  s_cbranch_scc0 L_now2
  s_mul_i32 s56, s3, 81920
  s_mul_i32 s57, s55, 160
  s_add_u32 s56, s56, s57
  s_add_u32 s40, s18, s56
  s_addc_u32 s41, s19, 0
  s_mov_b32 s42, 80800
  s_mov_b32 s43, 0x20000
  s_sub_u32 s70, s26, 2
  s_lshl_b32 s71, s70, 8
  s_mul_i32 s70, s70, 10240
  s_mov_b32 s59, 0
  s_lshl_b32 s57, s59, 6
  v_add_u32 v8, s57, v0
  v_mov_b32 v11, 1280
  s_lshl_b32 s57, s59, 10
  s_add_u32 s57, s57, s70
  v_mul_u32_u24 v9, 6554, v8
  v_lshrrev_b32 v9, 16, v9
  v_mul_u32_u24 v10, 10, v9
  v_sub_u32 v10, v8, v10
  v_lshlrev_b32 v10, 4, v10
  v_mad_u32_u24 v10, v9, v11, v10
  s_add_u32 m0, s57, 20480
  s_nop 0
  buffer_load_dwordx4 v10, s[40:43], 0 offen nt lds
  v_add_u32 v8, 64, v8
  v_mul_u32_u24 v9, 6554, v8
  v_lshrrev_b32 v9, 16, v9
  v_mul_u32_u24 v10, 10, v9
  v_sub_u32 v10, v8, v10
  v_lshlrev_b32 v10, 4, v10
  v_mad_u32_u24 v10, v9, v11, v10
  s_add_u32 m0, s57, 21504
  s_nop 0
  buffer_load_dwordx4 v10, s[40:43], 0 offen nt lds
  v_add_u32 v8, 64, v8
  v_mul_u32_u24 v9, 6554, v8
  v_lshrrev_b32 v9, 16, v9
  v_mul_u32_u24 v10, 10, v9
  v_sub_u32 v10, v8, v10
  v_lshlrev_b32 v10, 4, v10
  v_mad_u32_u24 v10, v9, v11, v10
  s_add_u32 m0, s57, 22528
  s_nop 0
  buffer_load_dwordx4 v10, s[40:43], 0 offen nt lds
  v_add_u32 v8, 64, v8
  v_mul_u32_u24 v9, 6554, v8
  v_lshrrev_b32 v9, 16, v9
  v_mul_u32_u24 v10, 10, v9
  v_sub_u32 v10, v8, v10
  v_lshlrev_b32 v10, 4, v10
  v_mad_u32_u24 v10, v9, v11, v10
  s_add_u32 m0, s57, 23552
  s_nop 0
  buffer_load_dwordx4 v10, s[40:43], 0 offen nt lds
  v_add_u32 v8, 64, v8
  v_mul_u32_u24 v9, 6554, v8
  v_lshrrev_b32 v9, 16, v9
  v_mul_u32_u24 v10, 10, v9
  v_sub_u32 v10, v8, v10
  v_lshlrev_b32 v10, 4, v10
  v_mad_u32_u24 v10, v9, v11, v10
  s_add_u32 m0, s57, 24576
  s_nop 0
  buffer_load_dwordx4 v10, s[40:43], 0 offen nt lds
  v_add_u32 v8, 64, v8
  v_mul_u32_u24 v9, 6554, v8
  v_lshrrev_b32 v9, 16, v9
  v_mul_u32_u24 v10, 10, v9
  v_sub_u32 v10, v8, v10
  v_lshlrev_b32 v10, 4, v10
  v_mad_u32_u24 v10, v9, v11, v10
  s_add_u32 m0, s57, 25600
  s_nop 0
  buffer_load_dwordx4 v10, s[40:43], 0 offen nt lds
  v_add_u32 v8, 64, v8
  v_mul_u32_u24 v9, 6554, v8
  v_lshrrev_b32 v9, 16, v9
  v_mul_u32_u24 v10, 10, v9
  v_sub_u32 v10, v8, v10
  v_lshlrev_b32 v10, 4, v10
  v_mad_u32_u24 v10, v9, v11, v10
  s_add_u32 m0, s57, 26624
  s_nop 0
  buffer_load_dwordx4 v10, s[40:43], 0 offen nt lds
  v_add_u32 v8, 64, v8
  v_mul_u32_u24 v9, 6554, v8
  v_lshrrev_b32 v9, 16, v9
  v_mul_u32_u24 v10, 10, v9
  v_sub_u32 v10, v8, v10
  v_lshlrev_b32 v10, 4, v10
  v_mad_u32_u24 v10, v9, v11, v10
  s_add_u32 m0, s57, 27648
  s_nop 0
  buffer_load_dwordx4 v10, s[40:43], 0 offen nt lds
  v_add_u32 v8, 64, v8
  v_mul_u32_u24 v9, 6554, v8
  v_lshrrev_b32 v9, 16, v9
  v_mul_u32_u24 v10, 10, v9
  v_sub_u32 v10, v8, v10
  v_lshlrev_b32 v10, 4, v10
  v_mad_u32_u24 v10, v9, v11, v10
  s_add_u32 m0, s57, 28672
  s_nop 0
  buffer_load_dwordx4 v10, s[40:43], 0 offen nt lds
  v_add_u32 v8, 64, v8
  v_mul_u32_u24 v9, 6554, v8
  v_lshrrev_b32 v9, 16, v9
  v_mul_u32_u24 v10, 10, v9
  v_sub_u32 v10, v8, v10
  v_lshlrev_b32 v10, 4, v10
  v_mad_u32_u24 v10, v9, v11, v10
  s_add_u32 m0, s57, 29696
  s_nop 0
  buffer_load_dwordx4 v10, s[40:43], 0 offen nt lds
L_now2:
  s_nop 4
  s_mul_i32 s58, s26, 6144
  s_add_u32 s58, s58, 54528
  s_add_u32 m0, s58, 0
  s_mov_b32 s57, 0x0
  buffer_load_dwordx4 v1, s[32:35], s57 offen nt lds
  s_add_u32 m0, s58, 1024
  s_mov_b32 s57, 0x2000
  buffer_load_dwordx4 v1, s[32:35], s57 offen nt lds
  s_add_u32 m0, s58, 2048
  s_mov_b32 s57, 0x800
  buffer_load_dwordx4 v1, s[32:35], s57 offen nt lds
  s_add_u32 m0, s58, 3072
  s_mov_b32 s57, 0x2800
  buffer_load_dwordx4 v1, s[32:35], s57 offen nt lds
  s_add_u32 m0, s58, 4096
  s_mov_b32 s57, 0x400
  buffer_load_dwordx4 v1, s[32:35], s57 offen nt lds
  s_add_u32 m0, s58, 5120
  s_mov_b32 s57, 0x2400
  buffer_load_dwordx4 v1, s[32:35], s57 offen nt lds
  buffer_load_dwordx4 v[80:83], v1, s[32:35], 0 offen offset:3072 nt
  s_mov_b32 s57, 0x2000
  buffer_load_dwordx4 v[84:87], v1, s[32:35], s57 offen offset:3072 nt
  s_mov_b32 s57, 0x4000
  buffer_load_dwordx4 v[88:91], v1, s[32:35], s57 offen offset:0 nt
  s_mov_b32 s57, 0x6000
  buffer_load_dwordx4 v[92:95], v1, s[32:35], s57 offen offset:0 nt
  s_mov_b32 s57, 0x4000
  buffer_load_dwordx4 v[96:99], v1, s[32:35], s57 offen offset:2048 nt
  s_mov_b32 s57, 0x6000
  buffer_load_dwordx4 v[100:103], v1, s[32:35], s57 offen offset:2048 nt
  s_mov_b32 s57, 0x4000
  buffer_load_dwordx4 v[104:107], v1, s[32:35], s57 offen offset:1024 nt
  s_mov_b32 s57, 0x6000
  buffer_load_dwordx4 v[108:111], v1, s[32:35], s57 offen offset:1024 nt
  s_mov_b32 s57, 0x4000
  buffer_load_dwordx4 v[112:115], v1, s[32:35], s57 offen offset:3072 nt
  s_mov_b32 s57, 0x6000
  buffer_load_dwordx4 v[116:119], v1, s[32:35], s57 offen offset:3072 nt
  s_branch L_qw
L_late0:
  s_nop 4
  s_mul_i32 s58, s26, 6144
  s_add_u32 s58, s58, 54528
  s_add_u32 m0, s58, 0
  s_mov_b32 s57, 0x0
  buffer_load_dwordx4 v1, s[32:35], s57 offen nt lds
  s_add_u32 m0, s58, 1024
  s_mov_b32 s57, 0x2000
  buffer_load_dwordx4 v1, s[32:35], s57 offen nt lds
  s_add_u32 m0, s58, 2048
  s_mov_b32 s57, 0x800
  buffer_load_dwordx4 v1, s[32:35], s57 offen nt lds
  s_add_u32 m0, s58, 3072
  s_mov_b32 s57, 0x2800
  buffer_load_dwordx4 v1, s[32:35], s57 offen nt lds
  s_add_u32 m0, s58, 4096
  s_mov_b32 s57, 0x400
  buffer_load_dwordx4 v1, s[32:35], s57 offen nt lds
  s_add_u32 m0, s58, 5120
  s_mov_b32 s57, 0x2400
  buffer_load_dwordx4 v1, s[32:35], s57 offen nt lds
  s_waitcnt lgkmcnt(0)
  s_and_b32 s27, s27, 0xfffffff0
  s_add_u32 s27, s27, 16
  s_or_b32 s14, s27, s15
  s_add_u32 s22, s27, 15
  v_mov_b32 v2, 54400
  s_mov_b32 s64, 0
L_qwl:
  s_nop 4
  ds_read_b32 v3, v2 offset:4
  s_waitcnt lgkmcnt(0)
  v_readfirstlane_b32 s15, v3
  s_nop 0
  s_and_b32 s56, s15, 0xff
  s_cmp_eq_u32 s56, 4
  s_cbranch_scc1 L_qwl_ok
  s_sleep 2
  s_add_u32 s64, s64, 1
  s_cmp_lt_u32 s64, 1048576
  s_cbranch_scc1 L_qwl
L_qwl_ok:
  s_nop 4
  s_lshr_b32 s15, s15, 8
  v_and_b32 v2, 15, v0
  v_lshlrev_b32 v2, 4, v2
  s_lshl_b32 s56, s72, 8
  v_add_u32 v2, s56, v2
  ds_read_b128 v[4:7], v2 offset:52736
  s_waitcnt lgkmcnt(0)
  s_waitcnt vmcnt(20)
  v_dot2_f32_bf16 v120, v16, v4, 0
  v_dot2_f32_bf16 v121, v20, v4, 0
  v_dot2_f32_bf16 v120, v17, v5, v120
  v_dot2_f32_bf16 v121, v21, v5, v121
  v_dot2_f32_bf16 v120, v18, v6, v120
  v_dot2_f32_bf16 v121, v22, v6, v121
  v_dot2_f32_bf16 v120, v19, v7, v120
  v_dot2_f32_bf16 v121, v23, v7, v121
  s_waitcnt vmcnt(18)
  v_dot2_f32_bf16 v122, v24, v4, 0
  v_dot2_f32_bf16 v123, v28, v4, 0
  v_dot2_f32_bf16 v122, v25, v5, v122
  v_dot2_f32_bf16 v123, v29, v5, v123
  v_dot2_f32_bf16 v122, v26, v6, v122
  v_dot2_f32_bf16 v123, v30, v6, v123
  v_dot2_f32_bf16 v122, v27, v7, v122
  v_dot2_f32_bf16 v123, v31, v7, v123
  v_add_f32_dpp v8, v120, v120 row_mirror row_mask:0xf bank_mask:0x3
  s_nop 1
  v_add_f32_dpp v8, v121, v121 row_mirror row_mask:0xf bank_mask:0xc
  s_waitcnt vmcnt(16)
  v_dot2_f32_bf16 v120, v32, v4, 0
  v_dot2_f32_bf16 v121, v36, v4, 0
  v_dot2_f32_bf16 v120, v33, v5, v120
  v_dot2_f32_bf16 v121, v37, v5, v121
  v_dot2_f32_bf16 v120, v34, v6, v120
  v_dot2_f32_bf16 v121, v38, v6, v121
  v_dot2_f32_bf16 v120, v35, v7, v120
  v_dot2_f32_bf16 v121, v39, v7, v121
  v_add_f32_dpp v9, v122, v122 row_mirror row_mask:0xf bank_mask:0x3
  s_nop 1
  v_add_f32_dpp v9, v123, v123 row_mirror row_mask:0xf bank_mask:0xc
  s_waitcnt vmcnt(14)
  v_dot2_f32_bf16 v122, v40, v4, 0
  v_dot2_f32_bf16 v123, v44, v4, 0
  v_dot2_f32_bf16 v122, v41, v5, v122
  v_dot2_f32_bf16 v123, v45, v5, v123
  v_dot2_f32_bf16 v122, v42, v6, v122
  v_dot2_f32_bf16 v123, v46, v6, v123
  v_dot2_f32_bf16 v122, v43, v7, v122
  v_dot2_f32_bf16 v123, v47, v7, v123
  v_add_f32_dpp v10, v120, v120 row_mirror row_mask:0xf bank_mask:0x3
  s_nop 1
  v_add_f32_dpp v10, v121, v121 row_mirror row_mask:0xf bank_mask:0xc
  s_waitcnt vmcnt(12)
  v_dot2_f32_bf16 v120, v48, v4, 0
  v_dot2_f32_bf16 v121, v52, v4, 0
  v_dot2_f32_bf16 v120, v49, v5, v120
  v_dot2_f32_bf16 v121, v53, v5, v121
  v_dot2_f32_bf16 v120, v50, v6, v120
  v_dot2_f32_bf16 v121, v54, v6, v121
  v_dot2_f32_bf16 v120, v51, v7, v120
  v_dot2_f32_bf16 v121, v55, v7, v121
  v_add_f32_dpp v11, v122, v122 row_mirror row_mask:0xf bank_mask:0x3
  s_nop 1
  v_add_f32_dpp v11, v123, v123 row_mirror row_mask:0xf bank_mask:0xc
  s_waitcnt vmcnt(10)
  v_dot2_f32_bf16 v122, v56, v4, 0
  v_dot2_f32_bf16 v123, v60, v4, 0
  v_dot2_f32_bf16 v122, v57, v5, v122
  v_dot2_f32_bf16 v123, v61, v5, v123
  v_dot2_f32_bf16 v122, v58, v6, v122
  v_dot2_f32_bf16 v123, v62, v6, v123
  v_dot2_f32_bf16 v122, v59, v7, v122
  v_dot2_f32_bf16 v123, v63, v7, v123
  v_add_f32_dpp v12, v120, v120 row_mirror row_mask:0xf bank_mask:0x3
  s_nop 1
  v_add_f32_dpp v12, v121, v121 row_mirror row_mask:0xf bank_mask:0xc
  s_waitcnt vmcnt(8)
  v_dot2_f32_bf16 v120, v64, v4, 0
  v_dot2_f32_bf16 v121, v68, v4, 0
  v_dot2_f32_bf16 v120, v65, v5, v120
  v_dot2_f32_bf16 v121, v69, v5, v121
  v_dot2_f32_bf16 v120, v66, v6, v120
  v_dot2_f32_bf16 v121, v70, v6, v121
  v_dot2_f32_bf16 v120, v67, v7, v120
  v_dot2_f32_bf16 v121, v71, v7, v121
  v_add_f32_dpp v13, v122, v122 row_mirror row_mask:0xf bank_mask:0x3
  s_nop 1
  v_add_f32_dpp v13, v123, v123 row_mirror row_mask:0xf bank_mask:0xc
  s_waitcnt vmcnt(6)
  v_dot2_f32_bf16 v122, v72, v4, 0
  v_dot2_f32_bf16 v123, v76, v4, 0
  v_dot2_f32_bf16 v122, v73, v5, v122
  v_dot2_f32_bf16 v123, v77, v5, v123
  v_dot2_f32_bf16 v122, v74, v6, v122
  v_dot2_f32_bf16 v123, v78, v6, v123
  v_dot2_f32_bf16 v122, v75, v7, v122
  v_dot2_f32_bf16 v123, v79, v7, v123
  v_add_f32_dpp v14, v120, v120 row_mirror row_mask:0xf bank_mask:0x3
  s_nop 1
  v_add_f32_dpp v14, v121, v121 row_mirror row_mask:0xf bank_mask:0xc
  v_add_f32_dpp v15, v122, v122 row_mirror row_mask:0xf bank_mask:0x3
  s_nop 1
  v_add_f32_dpp v15, v123, v123 row_mirror row_mask:0xf bank_mask:0xc
  buffer_load_dwordx4 v[80:83], v1, s[32:35], 0 offen offset:3072 nt
  s_mov_b32 s57, 0x2000
  buffer_load_dwordx4 v[84:87], v1, s[32:35], s57 offen offset:3072 nt
  s_mov_b32 s57, 0x4000
  buffer_load_dwordx4 v[88:91], v1, s[32:35], s57 offen offset:0 nt
  s_mov_b32 s57, 0x6000
  buffer_load_dwordx4 v[92:95], v1, s[32:35], s57 offen offset:0 nt
  s_mov_b32 s57, 0x4000
  buffer_load_dwordx4 v[96:99], v1, s[32:35], s57 offen offset:2048 nt
  s_mov_b32 s57, 0x6000
  buffer_load_dwordx4 v[100:103], v1, s[32:35], s57 offen offset:2048 nt
  s_mov_b32 s57, 0x4000
  buffer_load_dwordx4 v[104:107], v1, s[32:35], s57 offen offset:1024 nt
  s_mov_b32 s57, 0x6000
  buffer_load_dwordx4 v[108:111], v1, s[32:35], s57 offen offset:1024 nt
  s_mov_b32 s57, 0x4000
  buffer_load_dwordx4 v[112:115], v1, s[32:35], s57 offen offset:3072 nt
  s_mov_b32 s57, 0x6000
  buffer_load_dwordx4 v[116:119], v1, s[32:35], s57 offen offset:3072 nt
  s_cmp_ge_u32 s26, 15
  s_cbranch_scc0 L_notrig
  v_mov_b32 v40, 54400
  v_mov_b32 v41, 1
  s_mov_b64 exec, 1
  ds_add_u32 v40, v41 offset:12
  s_mov_b64 exec, -1
L_notrig:
  s_nop 4
  s_branch L_soft
L_qw:
  s_nop 4
  v_mov_b32 v2, 54400
  s_mov_b32 s64, 0
L_qwait:
  s_nop 4
  ds_read_b32 v3, v2 offset:4
  s_waitcnt lgkmcnt(0)
  v_readfirstlane_b32 s15, v3
  s_nop 0
  s_and_b32 s56, s15, 0xff
  s_cmp_eq_u32 s56, 4
  s_cbranch_scc1 L_qwait_ok
  s_sleep 2
  s_add_u32 s64, s64, 1
  s_cmp_lt_u32 s64, 1048576
  s_cbranch_scc1 L_qwait
L_qwait_ok:
  s_nop 4
  s_lshr_b32 s15, s15, 8
  v_and_b32 v2, 15, v0
  v_lshlrev_b32 v2, 4, v2
  s_lshl_b32 s56, s72, 8
  v_add_u32 v2, s56, v2
  ds_read_b128 v[4:7], v2 offset:52736
  s_waitcnt lgkmcnt(0)
  s_waitcnt vmcnt(30)
  v_dot2_f32_bf16 v120, v16, v4, 0
  v_dot2_f32_bf16 v121, v20, v4, 0
  v_dot2_f32_bf16 v120, v17, v5, v120
  v_dot2_f32_bf16 v121, v21, v5, v121
  v_dot2_f32_bf16 v120, v18, v6, v120
  v_dot2_f32_bf16 v121, v22, v6, v121
  v_dot2_f32_bf16 v120, v19, v7, v120
  v_dot2_f32_bf16 v121, v23, v7, v121
  s_waitcnt vmcnt(28)
  v_dot2_f32_bf16 v122, v24, v4, 0
  v_dot2_f32_bf16 v123, v28, v4, 0
  v_dot2_f32_bf16 v122, v25, v5, v122
  v_dot2_f32_bf16 v123, v29, v5, v123
  v_dot2_f32_bf16 v122, v26, v6, v122
  v_dot2_f32_bf16 v123, v30, v6, v123
  v_dot2_f32_bf16 v122, v27, v7, v122
  v_dot2_f32_bf16 v123, v31, v7, v123
  v_add_f32_dpp v8, v120, v120 row_mirror row_mask:0xf bank_mask:0x3
  s_nop 1
  v_add_f32_dpp v8, v121, v121 row_mirror row_mask:0xf bank_mask:0xc
  s_waitcnt vmcnt(26)
  v_dot2_f32_bf16 v120, v32, v4, 0
  v_dot2_f32_bf16 v121, v36, v4, 0
  v_dot2_f32_bf16 v120, v33, v5, v120
  v_dot2_f32_bf16 v121, v37, v5, v121
  v_dot2_f32_bf16 v120, v34, v6, v120
  v_dot2_f32_bf16 v121, v38, v6, v121
  v_dot2_f32_bf16 v120, v35, v7, v120
  v_dot2_f32_bf16 v121, v39, v7, v121
  v_add_f32_dpp v9, v122, v122 row_mirror row_mask:0xf bank_mask:0x3
  s_nop 1
  v_add_f32_dpp v9, v123, v123 row_mirror row_mask:0xf bank_mask:0xc
  s_waitcnt vmcnt(24)
  v_dot2_f32_bf16 v122, v40, v4, 0
  v_dot2_f32_bf16 v123, v44, v4, 0
  v_dot2_f32_bf16 v122, v41, v5, v122
  v_dot2_f32_bf16 v123, v45, v5, v123
  v_dot2_f32_bf16 v122, v42, v6, v122
  v_dot2_f32_bf16 v123, v46, v6, v123
  v_dot2_f32_bf16 v122, v43, v7, v122
  v_dot2_f32_bf16 v123, v47, v7, v123
  v_add_f32_dpp v10, v120, v120 row_mirror row_mask:0xf bank_mask:0x3
  s_nop 1
  v_add_f32_dpp v10, v121, v121 row_mirror row_mask:0xf bank_mask:0xc
  s_waitcnt vmcnt(22)
  v_dot2_f32_bf16 v120, v48, v4, 0
  v_dot2_f32_bf16 v121, v52, v4, 0
  v_dot2_f32_bf16 v120, v49, v5, v120
  v_dot2_f32_bf16 v121, v53, v5, v121
  v_dot2_f32_bf16 v120, v50, v6, v120
  v_dot2_f32_bf16 v121, v54, v6, v121
  v_dot2_f32_bf16 v120, v51, v7, v120
  v_dot2_f32_bf16 v121, v55, v7, v121
  v_add_f32_dpp v11, v122, v122 row_mirror row_mask:0xf bank_mask:0x3
  s_nop 1
  v_add_f32_dpp v11, v123, v123 row_mirror row_mask:0xf bank_mask:0xc
  s_waitcnt vmcnt(20)
  v_dot2_f32_bf16 v122, v56, v4, 0
  v_dot2_f32_bf16 v123, v60, v4, 0
  v_dot2_f32_bf16 v122, v57, v5, v122
  v_dot2_f32_bf16 v123, v61, v5, v123
  v_dot2_f32_bf16 v122, v58, v6, v122
  v_dot2_f32_bf16 v123, v62, v6, v123
  v_dot2_f32_bf16 v122, v59, v7, v122
  v_dot2_f32_bf16 v123, v63, v7, v123
  v_add_f32_dpp v12, v120, v120 row_mirror row_mask:0xf bank_mask:0x3
  s_nop 1
  v_add_f32_dpp v12, v121, v121 row_mirror row_mask:0xf bank_mask:0xc
  s_waitcnt vmcnt(18)
  v_dot2_f32_bf16 v120, v64, v4, 0
  v_dot2_f32_bf16 v121, v68, v4, 0
  v_dot2_f32_bf16 v120, v65, v5, v120
  v_dot2_f32_bf16 v121, v69, v5, v121
  v_dot2_f32_bf16 v120, v66, v6, v120
  v_dot2_f32_bf16 v121, v70, v6, v121
  v_dot2_f32_bf16 v120, v67, v7, v120
  v_dot2_f32_bf16 v121, v71, v7, v121
  v_add_f32_dpp v13, v122, v122 row_mirror row_mask:0xf bank_mask:0x3
  s_nop 1
  v_add_f32_dpp v13, v123, v123 row_mirror row_mask:0xf bank_mask:0xc
  s_waitcnt vmcnt(16)
  v_dot2_f32_bf16 v122, v72, v4, 0
  v_dot2_f32_bf16 v123, v76, v4, 0
  v_dot2_f32_bf16 v122, v73, v5, v122
  v_dot2_f32_bf16 v123, v77, v5, v123
  v_dot2_f32_bf16 v122, v74, v6, v122
  v_dot2_f32_bf16 v123, v78, v6, v123
  v_dot2_f32_bf16 v122, v75, v7, v122
  v_dot2_f32_bf16 v123, v79, v7, v123
  v_add_f32_dpp v14, v120, v120 row_mirror row_mask:0xf bank_mask:0x3
  s_nop 1
  v_add_f32_dpp v14, v121, v121 row_mirror row_mask:0xf bank_mask:0xc
  v_add_f32_dpp v15, v122, v122 row_mirror row_mask:0xf bank_mask:0x3
  s_nop 1
  v_add_f32_dpp v15, v123, v123 row_mirror row_mask:0xf bank_mask:0xc
L_soft:
  s_nop 4
  v_add_f32_dpp v124, v8, v8 row_half_mirror row_mask:0xf bank_mask:0x5
  v_add_f32_dpp v125, v10, v10 row_half_mirror row_mask:0xf bank_mask:0x5
  v_add_f32_dpp v126, v12, v12 row_half_mirror row_mask:0xf bank_mask:0x5
  v_add_f32_dpp v127, v14, v14 row_half_mirror row_mask:0xf bank_mask:0x5
  v_add_f32_dpp v124, v9, v9 row_half_mirror row_mask:0xf bank_mask:0xa
  v_add_f32_dpp v125, v11, v11 row_half_mirror row_mask:0xf bank_mask:0xa
  v_add_f32_dpp v126, v13, v13 row_half_mirror row_mask:0xf bank_mask:0xa
  v_add_f32_dpp v127, v15, v15 row_half_mirror row_mask:0xf bank_mask:0xa
  v_add_f32_dpp v124, v124, v124 quad_perm:[1,0,3,2] row_mask:0xf bank_mask:0xf
  v_add_f32_dpp v125, v125, v125 quad_perm:[1,0,3,2] row_mask:0xf bank_mask:0xf
  v_add_f32_dpp v126, v126, v126 quad_perm:[1,0,3,2] row_mask:0xf bank_mask:0xf
  v_add_f32_dpp v127, v127, v127 quad_perm:[1,0,3,2] row_mask:0xf bank_mask:0xf
  v_add_f32_dpp v124, v124, v124 quad_perm:[2,3,0,1] row_mask:0xf bank_mask:0xf
  v_add_f32_dpp v125, v125, v125 quad_perm:[2,3,0,1] row_mask:0xf bank_mask:0xf
  v_add_f32_dpp v126, v126, v126 quad_perm:[2,3,0,1] row_mask:0xf bank_mask:0xf
  v_add_f32_dpp v127, v127, v127 quad_perm:[2,3,0,1] row_mask:0xf bank_mask:0xf
  v_cvt_pk_bf16_f32 v120, v124, v125
  v_cvt_pk_bf16_f32 v121, v126, v127
  v_lshlrev_b32 v124, 16, v120
  v_and_b32 v125, s67, v120
  v_lshlrev_b32 v126, 16, v121
  v_and_b32 v127, s67, v121
  v_mul_f32 v124, s62, v124
  v_mul_f32 v125, s62, v125
  v_mul_f32 v126, s62, v126
  v_mul_f32 v127, s62, v127
  v_cvt_pk_bf16_f32 v120, v124, v125
  v_cvt_pk_bf16_f32 v121, v126, v127
  v_lshlrev_b32 v124, 16, v120
  v_and_b32 v125, s67, v120
  v_lshlrev_b32 v126, 16, v121
  v_and_b32 v127, s67, v121
  v_max3_f32 v122, v124, v125, v126
  v_max_f32 v122, v122, v127
  s_nop 1
  v_max_f32_dpp v122, v122, v122 row_ror:4 row_mask:0xf bank_mask:0xf
  s_nop 1
  v_max_f32_dpp v122, v122, v122 row_ror:8 row_mask:0xf bank_mask:0xf
  v_mov_b32 v123, v122
  s_nop 1
  v_permlane32_swap_b32 v122, v123
  v_max_f32 v122, v122, v123
  v_mov_b32 v123, v122
  s_nop 1
  v_permlane16_swap_b32 v122, v123
  v_max_f32 v122, v122, v123
  v_mov_b32 v4, v122
  v_sub_f32 v124, v124, v122
  v_sub_f32 v125, v125, v122
  v_sub_f32 v126, v126, v122
  v_sub_f32 v127, v127, v122
  v_mul_f32 v124, s63, v124
  v_mul_f32 v125, s63, v125
  v_mul_f32 v126, s63, v126
  v_mul_f32 v127, s63, v127
  v_exp_f32 v124, v124
  v_exp_f32 v125, v125
  v_exp_f32 v126, v126
  v_exp_f32 v127, v127
  v_add_f32 v120, v124, v125
  v_add_f32 v121, v126, v127
  v_cvt_pk_bf16_f32 v2, v124, v125
  v_cvt_pk_bf16_f32 v3, v126, v127
  v_add_f32 v5, v120, v121
  s_nop 1
  v_add_f32_dpp v5, v5, v5 row_ror:4 row_mask:0xf bank_mask:0xf
  s_nop 1
  v_add_f32_dpp v5, v5, v5 row_ror:8 row_mask:0xf bank_mask:0xf
  v_mov_b32 v121, v5
  s_nop 1
  v_permlane32_swap_b32 v5, v121
  v_add_f32 v5, v5, v121
  v_mov_b32 v121, v5
  s_nop 1
  v_permlane16_swap_b32 v5, v121
  v_add_f32 v5, v5, v121
  s_lshl_b32 s56, s73, 3
  v_mov_b32 v6, s56
  v_mov_b32 v7, 54400
  v_mov_b32 v121, 1
  s_mov_b64 exec, 1
  ds_write_b64 v6, v[4:5] offset:53760
  ds_add_u32 v7, v121 offset:16
  s_mov_b64 exec, -1
  v_lshlrev_b32 v6, 4, v0
  s_mul_i32 s58, s26, 6144
  s_add_u32 s58, s58, 54528
  v_add_u32 v6, s58, v6
  v_mov_b32 v8, 0
  v_mov_b32 v9, 0
  v_mov_b32 v10, 0
  v_mov_b32 v11, 0
  v_mov_b32 v12, 0
  v_mov_b32 v13, 0
  v_mov_b32 v14, 0
  v_mov_b32 v15, 0
  s_waitcnt vmcnt(10)
  ds_read_b128 v[16:19], v6 offset:0
  ds_read_b128 v[20:23], v6 offset:1024
  ds_read_b128 v[24:27], v6 offset:2048
  ds_read_b128 v[28:31], v6 offset:3072
  ds_read_b128 v[32:35], v6 offset:4096
  ds_read_b128 v[36:39], v6 offset:5120
  s_waitcnt lgkmcnt(4)
  v_perm_b32 v120, v20, v16, s60
  v_perm_b32 v121, v20, v16, s61
  v_perm_b32 v122, v21, v17, s60
  v_perm_b32 v123, v21, v17, s61
  v_perm_b32 v124, v22, v18, s60
  v_perm_b32 v125, v22, v18, s61
  v_perm_b32 v126, v23, v19, s60
  v_perm_b32 v127, v23, v19, s61
  v_dot2c_f32_bf16_dpp v8, v2, v120 row_newbcast:0 row_mask:0xf bank_mask:0xf
  v_dot2c_f32_bf16_dpp v9, v2, v121 row_newbcast:0 row_mask:0xf bank_mask:0xf
  v_dot2c_f32_bf16_dpp v10, v2, v122 row_newbcast:0 row_mask:0xf bank_mask:0xf
  v_dot2c_f32_bf16_dpp v11, v2, v123 row_newbcast:0 row_mask:0xf bank_mask:0xf
  v_dot2c_f32_bf16_dpp v12, v2, v124 row_newbcast:0 row_mask:0xf bank_mask:0xf
  v_dot2c_f32_bf16_dpp v13, v2, v125 row_newbcast:0 row_mask:0xf bank_mask:0xf
  v_dot2c_f32_bf16_dpp v14, v2, v126 row_newbcast:0 row_mask:0xf bank_mask:0xf
  v_dot2c_f32_bf16_dpp v15, v2, v127 row_newbcast:0 row_mask:0xf bank_mask:0xf
  s_waitcnt lgkmcnt(2)
  v_perm_b32 v120, v28, v24, s60
  v_perm_b32 v121, v28, v24, s61
  v_perm_b32 v122, v29, v25, s60
  v_perm_b32 v123, v29, v25, s61
  v_perm_b32 v124, v30, v26, s60
  v_perm_b32 v125, v30, v26, s61
  v_perm_b32 v126, v31, v27, s60
  v_perm_b32 v127, v31, v27, s61
  v_dot2c_f32_bf16_dpp v8, v2, v120 row_newbcast:4 row_mask:0xf bank_mask:0xf
  v_dot2c_f32_bf16_dpp v9, v2, v121 row_newbcast:4 row_mask:0xf bank_mask:0xf
  v_dot2c_f32_bf16_dpp v10, v2, v122 row_newbcast:4 row_mask:0xf bank_mask:0xf
  v_dot2c_f32_bf16_dpp v11, v2, v123 row_newbcast:4 row_mask:0xf bank_mask:0xf
  v_dot2c_f32_bf16_dpp v12, v2, v124 row_newbcast:4 row_mask:0xf bank_mask:0xf
  v_dot2c_f32_bf16_dpp v13, v2, v125 row_newbcast:4 row_mask:0xf bank_mask:0xf
  v_dot2c_f32_bf16_dpp v14, v2, v126 row_newbcast:4 row_mask:0xf bank_mask:0xf
  v_dot2c_f32_bf16_dpp v15, v2, v127 row_newbcast:4 row_mask:0xf bank_mask:0xf
  s_waitcnt lgkmcnt(0)
  v_perm_b32 v120, v36, v32, s60
  v_perm_b32 v121, v36, v32, s61
  v_perm_b32 v122, v37, v33, s60
  v_perm_b32 v123, v37, v33, s61
  v_perm_b32 v124, v38, v34, s60
  v_perm_b32 v125, v38, v34, s61
  v_perm_b32 v126, v39, v35, s60
  v_perm_b32 v127, v39, v35, s61
  v_dot2c_f32_bf16_dpp v8, v2, v120 row_newbcast:8 row_mask:0xf bank_mask:0xf
  v_dot2c_f32_bf16_dpp v9, v2, v121 row_newbcast:8 row_mask:0xf bank_mask:0xf
  v_dot2c_f32_bf16_dpp v10, v2, v122 row_newbcast:8 row_mask:0xf bank_mask:0xf
  v_dot2c_f32_bf16_dpp v11, v2, v123 row_newbcast:8 row_mask:0xf bank_mask:0xf
  v_dot2c_f32_bf16_dpp v12, v2, v124 row_newbcast:8 row_mask:0xf bank_mask:0xf
  v_dot2c_f32_bf16_dpp v13, v2, v125 row_newbcast:8 row_mask:0xf bank_mask:0xf
  v_dot2c_f32_bf16_dpp v14, v2, v126 row_newbcast:8 row_mask:0xf bank_mask:0xf
  v_dot2c_f32_bf16_dpp v15, v2, v127 row_newbcast:8 row_mask:0xf bank_mask:0xf
  s_waitcnt vmcnt(8)
  v_perm_b32 v120, v84, v80, s60
  v_perm_b32 v121, v84, v80, s61
  v_perm_b32 v122, v85, v81, s60
  v_perm_b32 v123, v85, v81, s61
  v_perm_b32 v124, v86, v82, s60
  v_perm_b32 v125, v86, v82, s61
  v_perm_b32 v126, v87, v83, s60
  v_perm_b32 v127, v87, v83, s61
  v_dot2c_f32_bf16_dpp v8, v2, v120 row_newbcast:12 row_mask:0xf bank_mask:0xf
  v_dot2c_f32_bf16_dpp v9, v2, v121 row_newbcast:12 row_mask:0xf bank_mask:0xf
  v_dot2c_f32_bf16_dpp v10, v2, v122 row_newbcast:12 row_mask:0xf bank_mask:0xf
  v_dot2c_f32_bf16_dpp v11, v2, v123 row_newbcast:12 row_mask:0xf bank_mask:0xf
  v_dot2c_f32_bf16_dpp v12, v2, v124 row_newbcast:12 row_mask:0xf bank_mask:0xf
  v_dot2c_f32_bf16_dpp v13, v2, v125 row_newbcast:12 row_mask:0xf bank_mask:0xf
  v_dot2c_f32_bf16_dpp v14, v2, v126 row_newbcast:12 row_mask:0xf bank_mask:0xf
  v_dot2c_f32_bf16_dpp v15, v2, v127 row_newbcast:12 row_mask:0xf bank_mask:0xf
  s_waitcnt vmcnt(6)
  v_perm_b32 v120, v92, v88, s60
  v_perm_b32 v121, v92, v88, s61
  v_perm_b32 v122, v93, v89, s60
  v_perm_b32 v123, v93, v89, s61
  v_perm_b32 v124, v94, v90, s60
  v_perm_b32 v125, v94, v90, s61
  v_perm_b32 v126, v95, v91, s60
  v_perm_b32 v127, v95, v91, s61
  v_dot2c_f32_bf16_dpp v8, v3, v120 row_newbcast:0 row_mask:0xf bank_mask:0xf
  v_dot2c_f32_bf16_dpp v9, v3, v121 row_newbcast:0 row_mask:0xf bank_mask:0xf
  v_dot2c_f32_bf16_dpp v10, v3, v122 row_newbcast:0 row_mask:0xf bank_mask:0xf
  v_dot2c_f32_bf16_dpp v11, v3, v123 row_newbcast:0 row_mask:0xf bank_mask:0xf
  v_dot2c_f32_bf16_dpp v12, v3, v124 row_newbcast:0 row_mask:0xf bank_mask:0xf
  v_dot2c_f32_bf16_dpp v13, v3, v125 row_newbcast:0 row_mask:0xf bank_mask:0xf
  v_dot2c_f32_bf16_dpp v14, v3, v126 row_newbcast:0 row_mask:0xf bank_mask:0xf
  v_dot2c_f32_bf16_dpp v15, v3, v127 row_newbcast:0 row_mask:0xf bank_mask:0xf
  s_waitcnt vmcnt(4)
  v_perm_b32 v120, v100, v96, s60
  v_perm_b32 v121, v100, v96, s61
  v_perm_b32 v122, v101, v97, s60
  v_perm_b32 v123, v101, v97, s61
  v_perm_b32 v124, v102, v98, s60
  v_perm_b32 v125, v102, v98, s61
  v_perm_b32 v126, v103, v99, s60
  v_perm_b32 v127, v103, v99, s61
  v_dot2c_f32_bf16_dpp v8, v3, v120 row_newbcast:4 row_mask:0xf bank_mask:0xf
  v_dot2c_f32_bf16_dpp v9, v3, v121 row_newbcast:4 row_mask:0xf bank_mask:0xf
  v_dot2c_f32_bf16_dpp v10, v3, v122 row_newbcast:4 row_mask:0xf bank_mask:0xf
  v_dot2c_f32_bf16_dpp v11, v3, v123 row_newbcast:4 row_mask:0xf bank_mask:0xf
  v_dot2c_f32_bf16_dpp v12, v3, v124 row_newbcast:4 row_mask:0xf bank_mask:0xf
  v_dot2c_f32_bf16_dpp v13, v3, v125 row_newbcast:4 row_mask:0xf bank_mask:0xf
  v_dot2c_f32_bf16_dpp v14, v3, v126 row_newbcast:4 row_mask:0xf bank_mask:0xf
  v_dot2c_f32_bf16_dpp v15, v3, v127 row_newbcast:4 row_mask:0xf bank_mask:0xf
  s_waitcnt vmcnt(2)
  v_perm_b32 v120, v108, v104, s60
  v_perm_b32 v121, v108, v104, s61
  v_perm_b32 v122, v109, v105, s60
  v_perm_b32 v123, v109, v105, s61
  v_perm_b32 v124, v110, v106, s60
  v_perm_b32 v125, v110, v106, s61
  v_perm_b32 v126, v111, v107, s60
  v_perm_b32 v127, v111, v107, s61
  v_dot2c_f32_bf16_dpp v8, v3, v120 row_newbcast:8 row_mask:0xf bank_mask:0xf
  v_dot2c_f32_bf16_dpp v9, v3, v121 row_newbcast:8 row_mask:0xf bank_mask:0xf
  v_dot2c_f32_bf16_dpp v10, v3, v122 row_newbcast:8 row_mask:0xf bank_mask:0xf
  v_dot2c_f32_bf16_dpp v11, v3, v123 row_newbcast:8 row_mask:0xf bank_mask:0xf
  v_dot2c_f32_bf16_dpp v12, v3, v124 row_newbcast:8 row_mask:0xf bank_mask:0xf
  v_dot2c_f32_bf16_dpp v13, v3, v125 row_newbcast:8 row_mask:0xf bank_mask:0xf
  v_dot2c_f32_bf16_dpp v14, v3, v126 row_newbcast:8 row_mask:0xf bank_mask:0xf
  v_dot2c_f32_bf16_dpp v15, v3, v127 row_newbcast:8 row_mask:0xf bank_mask:0xf
  s_waitcnt vmcnt(0)
  v_perm_b32 v120, v116, v112, s60
  v_perm_b32 v121, v116, v112, s61
  v_perm_b32 v122, v117, v113, s60
  v_perm_b32 v123, v117, v113, s61
  v_perm_b32 v124, v118, v114, s60
  v_perm_b32 v125, v118, v114, s61
  v_perm_b32 v126, v119, v115, s60
  v_perm_b32 v127, v119, v115, s61
  v_dot2c_f32_bf16_dpp v8, v3, v120 row_newbcast:12 row_mask:0xf bank_mask:0xf
  v_dot2c_f32_bf16_dpp v9, v3, v121 row_newbcast:12 row_mask:0xf bank_mask:0xf
  v_dot2c_f32_bf16_dpp v10, v3, v122 row_newbcast:12 row_mask:0xf bank_mask:0xf
  v_dot2c_f32_bf16_dpp v11, v3, v123 row_newbcast:12 row_mask:0xf bank_mask:0xf
  v_dot2c_f32_bf16_dpp v12, v3, v124 row_newbcast:12 row_mask:0xf bank_mask:0xf
  v_dot2c_f32_bf16_dpp v13, v3, v125 row_newbcast:12 row_mask:0xf bank_mask:0xf
  v_dot2c_f32_bf16_dpp v14, v3, v126 row_newbcast:12 row_mask:0xf bank_mask:0xf
  v_dot2c_f32_bf16_dpp v15, v3, v127 row_newbcast:12 row_mask:0xf bank_mask:0xf
  v_permlane32_swap_b32 v8, v9
  v_permlane32_swap_b32 v10, v11
  v_permlane32_swap_b32 v12, v13
  v_permlane32_swap_b32 v14, v15
  v_add_f32 v8, v8, v9
  v_add_f32 v10, v10, v11
  v_add_f32 v12, v12, v13
  v_add_f32 v14, v14, v15
  v_permlane16_swap_b32 v8, v10
  s_nop 0
  v_permlane16_swap_b32 v12, v14
  v_add_f32 v8, v8, v10
  v_add_f32 v12, v12, v14
  v_and_b32 v2, 15, v0
  v_lshlrev_b32 v2, 5, v2
  v_bfe_u32 v3, v0, 4, 1
  v_lshl_add_u32 v2, v3, 3, v2
  v_lshrrev_b32 v3, 5, v0
  v_lshl_add_u32 v2, v3, 2, v2
  s_mul_i32 s56, s73, 576
  s_add_u32 s56, s56, 40960
  v_add_u32 v2, s56, v2
  ds_write2_b32 v2, v8, v12 offset0:0 offset1:4
  s_cmp_lt_u32 s3, 27
  s_cbranch_scc0 L_nofin
  s_lshl_b32 s68, s3, 13
  s_add_u32 s68, s68, 1245184
  s_add_u32 s69, s68, 0x1000
  v_lshlrev_b32 v2, 4, v0
  s_mov_b32 s64, 0
  s_setprio 3
L_hpoll:
  s_nop 4
  buffer_load_dwordx4 v[40:43], v2, s[36:39], s68 offen offset:0 sc1
  buffer_load_dwordx4 v[44:47], v2, s[36:39], s68 offen offset:1024 sc1
  buffer_load_dwordx4 v[48:51], v2, s[36:39], s68 offen offset:2048 sc1
  buffer_load_dwordx4 v[52:55], v2, s[36:39], s68 offen offset:3072 sc1
  buffer_load_dwordx4 v[56:59], v2, s[36:39], s69 offen offset:0 sc1
  buffer_load_dwordx4 v[60:63], v2, s[36:39], s69 offen offset:1024 sc1
  buffer_load_dwordx4 v[64:67], v2, s[36:39], s69 offen offset:2048 sc1
  buffer_load_dwordx4 v[68:71], v2, s[36:39], s69 offen offset:3072 sc1
  s_waitcnt vmcnt(0)
  v_min3_u32 v126, v41, v43, v45
  v_min3_u32 v126, v126, v47, v49
  v_min3_u32 v126, v126, v51, v53
  v_min3_u32 v126, v126, v55, v57
  v_min3_u32 v126, v126, v59, v61
  v_min3_u32 v126, v126, v63, v65
  v_min3_u32 v126, v126, v67, v69
  v_min3_u32 v126, v126, v71, v71
  v_max3_u32 v127, v41, v43, v45
  v_max3_u32 v127, v127, v47, v49
  v_max3_u32 v127, v127, v51, v53
  v_max3_u32 v127, v127, v55, v57
  v_max3_u32 v127, v127, v59, v61
  v_max3_u32 v127, v127, v63, v65
  v_max3_u32 v127, v127, v67, v69
  v_max3_u32 v127, v127, v71, v71
  v_cmp_ne_u32 vcc, s27, v126
  v_cmp_ne_u32 s[58:59], s27, v127
  s_nop 0
  s_or_b64 s[58:59], vcc, s[58:59]
  s_cbranch_scc0 L_hpoll_ok
  s_add_u32 s64, s64, 1
  s_cmp_lt_u32 s64, 1048576
  s_cbranch_scc1 L_hpoll
L_hpoll_ok:
  s_nop 4
  s_setprio 0
  v_add_f32 v40, v40, v44
  v_add_f32 v42, v42, v46
  v_add_f32 v48, v48, v52
  v_add_f32 v50, v50, v54
  v_add_f32 v56, v56, v60
  v_add_f32 v58, v58, v62
  v_add_f32 v64, v64, v68
  v_add_f32 v66, v66, v70
  v_add_f32 v40, v40, v48
  v_add_f32 v42, v42, v50
  v_add_f32 v56, v56, v64
  v_add_f32 v58, v58, v66
  v_add_f32 v40, v40, v56
  v_add_f32 v42, v42, v58
  v_cvt_pk_bf16_f32 v4, v40, v42
  v_lshlrev_b32 v5, 16, v4
  v_and_b32 v6, s67, v4
  v_mul_f32 v7, s63, v5
  v_mul_f32 v8, s63, v6
  v_exp_f32 v7, -v7
  v_exp_f32 v8, -v8
  v_add_f32 v7, 1.0, v7
  v_add_f32 v8, 1.0, v8
  v_rcp_f32 v9, v7
  v_rcp_f32 v10, v8
  v_mul_f32 v11, v5, v9
  v_mul_f32 v12, v6, v10
  v_fma_f32 v5, -v11, v7, v5
  v_fma_f32 v6, -v12, v8, v6
  v_fma_f32 v11, v5, v9, v11
  v_fma_f32 v12, v6, v10, v12
  v_cvt_pk_bf16_f32 v4, v11, v12
  v_lshlrev_b32 v2, 2, v0
  v_add_u32 v2, s71, v2
  ds_write_b32 v2, v4 offset:53248
  v_mov_b32 v2, 54400
  v_mov_b32 v3, 1
  s_mov_b64 exec, 1
  ds_add_u32 v2, v3 offset:20
  s_mov_b64 exec, -1
L_nofin:
  s_nop 4
  s_mov_b32 s9, 0x0c0c0400
  s_mov_b32 s10, 0x04000c0c
  s_mov_b32 s18, 0xffffff00
  s_cmp_lt_u32 s26, 8
  s_cbranch_scc0 L_pre_hi
  s_cmp_lt_u32 s26, 5
  s_cbranch_scc0 L_nobf
  v_lshrrev_b32 v3, 4, v0
  v_lshlrev_b32 v3, 3, v3
  v_bfe_u32 v5, v0, 2, 2
  v_add_u32 v3, v3, v5
  v_mul_u32_u24 v3, 160, v3
  v_and_b32 v5, 3, v0
  v_lshl_add_u32 v3, v5, 3, v3
  s_lshl_b32 s56, s26, 5
  v_add_u32 v112, s56, v3
L_nobf:
  s_nop 4
  v_lshrrev_b32 v2, 3, v0
  v_and_b32 v3, 7, v0
  v_lshrrev_b32 v4, 4, v0
  v_lshlrev_b32 v5, 4, v3
  s_mul_i32 s56, s53, 576
  s_lshl_b32 s57, s54, 7
  s_add_u32 s56, s56, s57
  s_add_u32 s56, s56, 40960
  v_mul_u32_u24 v100, 1152, v2
  v_add_u32 v100, v100, v5
  v_add_u32 v100, s56, v100
  s_lshl_b32 s56, s53, 5
  s_add_u32 s56, s56, 53760
  v_lshlrev_b32 v105, 2, v2
  v_add_u32 v105, s56, v105
  s_lshl_b32 s56, s53, 2
  s_add_u32 s56, s56, 54464
  v_lshlrev_b32 v101, 3, v2
  v_add_u32 v101, s56, v101
  v_lshl_add_u32 v102, v4, 2, v5
  v_lshlrev_b32 v6, 3, v4
  v_lshrrev_b32 v103, v6, s27
  v_lshl_add_u32 v104, v2, 9, v5
  s_lshl_b32 s56, s53, 8
  s_lshl_b32 s57, s54, 6
  s_add_u32 s56, s56, s57
  s_add_u32 s56, s56, 53888
  v_lshlrev_b32 v106, 3, v3
  v_lshl_add_u32 v106, v4, 1, v106
  v_add_u32 v106, s56, v106
  v_and_b32 v6, 1, v0
  v_lshlrev_b32 v107, 8, v6
  v_lshl_add_u32 v107, v4, 4, v107
  v_add_u32 v107, 53888, v107
  v_lshlrev_b32 v108, 6, v6
  v_lshl_add_u32 v108, v4, 4, v108
  v_lshlrev_b32 v113, 7, v6
  v_lshl_add_u32 v113, v4, 4, v113
  v_mov_b32 v109, s27
  v_mov_b32 v110, 54400
  v_mov_b32 v111, 1
  s_lshl_b32 s56, s52, 1
  s_add_u32 s56, s56, s53
  s_lshl_b32 s57, s54, 7
  s_lshl_b32 s6, s56, 12
  s_add_u32 s6, s6, s57
  s_add_u32 s6, s6, 65536
  s_lshl_b32 s4, s55, 9
  s_add_u32 s4, s4, s6
  s_lshl_b32 s7, s56, 7
  s_add_u32 s7, s7, 327680
  s_lshl_b32 s5, s55, 4
  s_add_u32 s5, s5, s7
  s_mul_i32 s8, s55, 5
  s_add_u32 s8, s8, s26
  s_lshl_b32 s8, s8, 6
  s_add_u32 s8, s8, s52
  s_lshl_b32 s8, s8, 7
  s_add_u32 s8, s8, 393216
  s_movk_i32 s11, 0xff
  s_mov_b32 s12, 0x07060500
  s_mov_b32 s13, 0x07060501
  s_mov_b32 s16, 0x07060502
  s_mov_b32 s17, 0x07060503
  s_and_b32 s58, s2, 7
  s_lshl_b32 s58, s58, 2
  s_bfe_u32 s59, s2, 0x20006
  s_add_u32 s58, s58, s59
  s_mov_b32 s56, 0xf030f0f
  s_lshl_b32 s57, 1, s58
  s_sub_u32 s59, s57, 1
  s_and_b32 s59, s59, s56
  s_bcnt1_i32_b32 s19, s59
  s_lshl_b32 s19, s19, 1
  s_and_b32 s57, s57, s56
  s_cselect_b32 s19, s19, 31
  s_cmp_lt_u32 s26, 5
  s_cbranch_scc0 L_nofpre
  s_cmp_lt_u32 s19, 27
  s_cselect_b32 s58, 1, 0
  s_cmp_lt_u32 s19, 26
  s_cselect_b32 s58, 2, s58
  v_mov_b32 v56, 0
  v_mov_b32 v57, 0
  v_mov_b32 v58, 0
  v_mov_b32 v59, 0
  s_cmp_eq_u32 s58, 0
  s_cbranch_scc1 L_nofpre
  s_mov_b32 s64, 0
L_fw:
  s_nop 4
  ds_read_b32 v3, v110 offset:20
  s_waitcnt lgkmcnt(0)
  v_readfirstlane_b32 s56, v3
  s_nop 0
  s_cmp_eq_u32 s56, s58
  s_cbranch_scc1 L_fw_ok
  s_sleep 2
  s_add_u32 s64, s64, 1
  s_cmp_lt_u32 s64, 1048576
  s_cbranch_scc1 L_fw
L_fw_ok:
  s_nop 4
  ds_read_b64_tr_b16 v[64:65], v112 offset:20480
  ds_read_b64_tr_b16 v[66:67], v112 offset:21120
  ds_read_b128 v[72:75], v113 offset:53248
  ds_read_b64_tr_b16 v[68:69], v112 offset:25600
  ds_read_b64_tr_b16 v[70:71], v112 offset:26240
  ds_read_b128 v[76:79], v113 offset:53312
  s_waitcnt lgkmcnt(3)
  v_mfma_f32_16x16x32_bf16 v[56:59], v[64:67], v[72:75], v[56:59]
  s_waitcnt lgkmcnt(0)
  v_mfma_f32_16x16x32_bf16 v[56:59], v[68:71], v[76:79], v[56:59]
  s_cmp_eq_u32 s58, 2
  s_cbranch_scc0 L_nofpre
  s_nop 7
  ds_read_b64_tr_b16 v[64:65], v112 offset:30720
  ds_read_b64_tr_b16 v[66:67], v112 offset:31360
  ds_read_b128 v[72:75], v113 offset:53504
  ds_read_b64_tr_b16 v[68:69], v112 offset:35840
  ds_read_b64_tr_b16 v[70:71], v112 offset:36480
  ds_read_b128 v[76:79], v113 offset:53568
  s_waitcnt lgkmcnt(3)
  v_mfma_f32_16x16x32_bf16 v[56:59], v[64:67], v[72:75], v[56:59]
  s_waitcnt lgkmcnt(0)
  v_mfma_f32_16x16x32_bf16 v[56:59], v[68:71], v[76:79], v[56:59]
L_nofpre:
  s_nop 4
  s_cmp_eq_u32 s26, 7
  s_cbranch_scc0 L_nohelp
  s_lshl_b32 s58, s52, 3
  s_add_u32 s58, s58, s55
  s_lshl_b32 s58, s58, 10
  s_add_u32 s58, s58, 1507328
  v_lshlrev_b32 v68, 4, v0
  buffer_load_dwordx4 v[72:75], v68, s[36:39], s58 offen sc1
  v_mov_b32 v2, 54400
  s_mov_b32 s64, 0
L_mlw:
  s_nop 4
  ds_read_b32 v3, v2 offset:16
  s_waitcnt lgkmcnt(0)
  v_readfirstlane_b32 s56, v3
  s_nop 0
  s_cmp_eq_u32 s56, 16
  s_cbranch_scc1 L_mlw_ok
  s_sleep 2
  s_add_u32 s64, s64, 1
  s_cmp_lt_u32 s64, 1048576
  s_cbranch_scc1 L_mlw
L_mlw_ok:
  s_nop 4
  v_and_b32 v2, 15, v0
  v_lshlrev_b32 v3, 3, v2
  ds_read_b64 v[36:37], v3 offset:53760
  v_lshlrev_b32 v64, 2, v2
  v_and_b32 v4, 1, v0
  v_lshlrev_b32 v65, 7, v4
  v_bfe_u32 v4, v0, 1, 3
  v_lshl_add_u32 v65, v4, 10, v65
  v_lshrrev_b32 v4, 4, v0
  v_lshl_add_u32 v65, v4, 8, v65
  s_lshl_b32 s58, s52, 13
  s_add_u32 s58, s58, 1507328
  s_lshl_b32 s59, s55, 4
  s_add_u32 s59, s59, s58
  v_mov_b32 v67, -1
  s_waitcnt lgkmcnt(0)
  v_max_f32_dpp v38, v36, v36 row_ror:8 row_mask:0xf bank_mask:0xf
  s_nop 1
  v_max_f32_dpp v38, v38, v38 row_ror:4 row_mask:0xf bank_mask:0xf
  s_nop 1
  v_max_f32_dpp v38, v38, v38 row_ror:2 row_mask:0xf bank_mask:0xf
  v_sub_f32 v35, v36, v38
  v_mul_f32 v35, s63, v35
  v_exp_f32 v35, v35
  s_nop 0
  v_mul_f32 v37, v35, v37
  s_nop 1
  v_add_f32_dpp v37, v37, v37 row_ror:8 row_mask:0xf bank_mask:0xf
  s_nop 1
  v_add_f32_dpp v37, v37, v37 row_ror:4 row_mask:0xf bank_mask:0xf
  s_nop 1
  v_add_f32_dpp v37, v37, v37 row_ror:2 row_mask:0xf bank_mask:0xf
  v_mov_b32 v60, v38
  v_mov_b32 v61, v37
  v_mov_b32 v62, s27
  v_mov_b32 v63, s27
  s_mov_b32 exec_lo, 0xffff
  s_mov_b32 exec_hi, 0x0
  s_cmp_eq_u32 s15, 0
  s_cbranch_scc0 L_hslow
  buffer_store_dwordx4 v[60:63], v65, s[36:39], s59 offen
  s_branch L_hg0
L_hslow:
  s_nop 4
  buffer_store_dwordx4 v[60:63], v65, s[36:39], s59 offen sc1
L_hg0:
  s_nop 4
  s_mov_b64 exec, 0xffff
  ds_write_b32 v64, v35 offset:54464
  ds_write_b32 v64, v67 offset:53760
  s_mov_b64 exec, 3
  v_lshlrev_b32 v66, 1, v64
  ds_write_b64 v66, v[60:61] offset:54432
  s_mov_b64 exec, -1
L_nohelp:
  s_nop 4
  s_mov_b32 s64, 0
  s_branch L_barD
L_pre_hi:
  s_nop 4
  s_lshl_b32 s65, s52, 3
  s_add_u32 s65, s65, s55
  s_lshl_b32 s65, s65, 10
  s_and_b32 s66, s26, 1
  s_lshl_b32 s66, s66, 7
  s_add_u32 s65, s65, s66
  s_add_u32 s65, s65, 1507328
  s_lshr_b32 s66, s66, 4
  s_add_u32 s66, s66, 54432
  v_mov_b32 v104, s66
  s_lshl_b32 s20, 1, s55
  s_mov_b32 s21, 0
  s_xor_b32 s22, s20, 0xff
  s_mov_b32 s23, 0
  s_sub_u32 s59, s26, 8
  s_cmp_lt_u32 s59, 4
  s_cbranch_scc0 L_nowl
  s_mul_i32 s59, s59, 5
  s_lshl_b32 s57, s59, 6
  v_add_u32 v8, s57, v0
  v_mov_b32 v11, 1280
  v_mul_u32_u24 v9, 6554, v8
  v_lshrrev_b32 v9, 16, v9
  v_mul_u32_u24 v10, 10, v9
  v_sub_u32 v10, v8, v10
  v_lshlrev_b32 v10, 4, v10
  v_mad_u32_u24 v16, v9, v11, v10
  v_add_u32 v8, 64, v8
  v_mul_u32_u24 v9, 6554, v8
  v_lshrrev_b32 v9, 16, v9
  v_mul_u32_u24 v10, 10, v9
  v_sub_u32 v10, v8, v10
  v_lshlrev_b32 v10, 4, v10
  v_mad_u32_u24 v17, v9, v11, v10
  v_add_u32 v8, 64, v8
  v_mul_u32_u24 v9, 6554, v8
  v_lshrrev_b32 v9, 16, v9
  v_mul_u32_u24 v10, 10, v9
  v_sub_u32 v10, v8, v10
  v_lshlrev_b32 v10, 4, v10
  v_mad_u32_u24 v18, v9, v11, v10
  v_add_u32 v8, 64, v8
  v_mul_u32_u24 v9, 6554, v8
  v_lshrrev_b32 v9, 16, v9
  v_mul_u32_u24 v10, 10, v9
  v_sub_u32 v10, v8, v10
  v_lshlrev_b32 v10, 4, v10
  v_mad_u32_u24 v19, v9, v11, v10
  v_add_u32 v8, 64, v8
  v_mul_u32_u24 v9, 6554, v8
  v_lshrrev_b32 v9, 16, v9
  v_mul_u32_u24 v10, 10, v9
  v_sub_u32 v10, v8, v10
  v_lshlrev_b32 v10, 4, v10
  v_mad_u32_u24 v20, v9, v11, v10
  s_lshl_b32 s58, s59, 10
  v_mov_b32 v2, 54400
  s_mov_b32 s64, 0
L_trig:
  s_nop 4
  ds_read_b32 v3, v2 offset:12
  s_waitcnt lgkmcnt(0)
  v_readfirstlane_b32 s56, v3
  s_nop 0
  s_cmp_eq_u32 s56, 1
  s_cbranch_scc1 L_trig_ok
  s_sleep 1
  s_add_u32 s64, s64, 1
  s_cmp_lt_u32 s64, 1048576
  s_cbranch_scc1 L_trig
L_trig_ok:
  s_nop 4
  s_add_u32 m0, s58, 0
  s_nop 0
  buffer_load_dwordx4 v16, s[80:83], 0 offen nt lds
  s_add_u32 m0, s58, 1024
  s_nop 0
  buffer_load_dwordx4 v17, s[80:83], 0 offen nt lds
  s_add_u32 m0, s58, 2048
  s_nop 0
  buffer_load_dwordx4 v18, s[80:83], 0 offen nt lds
  s_add_u32 m0, s58, 3072
  s_nop 0
  buffer_load_dwordx4 v19, s[80:83], 0 offen nt lds
  s_add_u32 m0, s58, 4096
  s_nop 0
  buffer_load_dwordx4 v20, s[80:83], 0 offen nt lds
L_nowl:
  s_nop 4
  s_cmp_eq_u32 s26, 8
  s_cbranch_scc0 L_barD
  s_and_b32 s56, s2, 7
  s_bfe_u32 s57, s2, 0x20006
  s_lshl_b32 s57, s57, 3
  s_add_u32 s57, s57, s56
  s_bitcmp1_b32 s57, 0
  s_cbranch_scc1 L_barD
  s_cmp_lt_u32 s57, 20
  s_cbranch_scc0 L_barD
  s_lshr_b32 s56, s57, 1
  s_cmp_ge_u32 s56, 5
  s_cselect_b32 s57, 1, 0
  s_mul_i32 s58, s57, 5
  s_sub_u32 s56, s56, s58
  v_lshrrev_b32 v2, 2, v0
  v_lshlrev_b32 v100, 7, v2
  v_and_b32 v3, 3, v0
  v_lshl_add_u32 v100, v3, 4, v100
  s_lshl_b32 s58, s57, 6
  v_add_u32 v100, s58, v100
  s_mul_i32 s4, s55, 5
  s_add_u32 s4, s4, s56
  s_lshl_b32 s4, s4, 13
  s_add_u32 s4, s4, 393216
  s_add_u32 s5, s4, 0x1000
  s_mul_i32 s58, s57, 640
  s_mul_i32 s59, s55, 80
  s_add_u32 s58, s58, s59
  s_lshl_b32 s59, s56, 4
  s_add_u32 s58, s58, s59
  v_lshlrev_b32 v2, 2, v3
  v_bfe_u32 v3, v0, 4, 1
  v_add_u32 v2, v2, v3
  v_bfe_u32 v3, v0, 5, 1
  v_lshl_add_u32 v2, v3, 1, v2
  v_add_u32 v2, s58, v2
  v_lshlrev_b32 v101, 1, v2
  buffer_load_ushort v6, v101, s[44:47], 0 offen
  s_and_b32 s6, s27, 0xffff
  s_and_b32 s7, s27, 0xffff0000
  s_mov_b32 s64, 0
L_barD:
  s_waitcnt lgkmcnt(0)
  s_barrier
  s_cmp_lt_u32 s26, 8
  s_cbranch_scc0 L_hiE
  ds_read_b32 v35, v101
  ds_read_b128 v[40:43], v100
  s_cmp_eq_u32 s15, 0
  s_waitcnt lgkmcnt(0)
  v_mul_f32 v40, v35, v40
  v_mul_f32 v41, v35, v41
  v_mul_f32 v42, v35, v42
  v_mul_f32 v43, v35, v43
  v_add_f32_dpp v40, v40, v40 row_ror:8 row_mask:0xf bank_mask:0xf
  v_add_f32_dpp v41, v41, v41 row_ror:8 row_mask:0xf bank_mask:0xf
  v_add_f32_dpp v42, v42, v42 row_ror:8 row_mask:0xf bank_mask:0xf
  v_add_f32_dpp v43, v43, v43 row_ror:8 row_mask:0xf bank_mask:0xf
  v_permlane16_swap_b32 v40, v41
  s_nop 0
  v_permlane16_swap_b32 v42, v43
  v_add_f32 v40, v40, v41
  v_add_f32 v42, v42, v43
  s_nop 1
  v_permlane32_swap_b32 v40, v42
  v_add_f32 v40, v40, v42
  v_bfi_b32 v44, s11, v103, v40
  s_mov_b32 exec_lo, 0x00ff00ff
  s_mov_b32 exec_hi, 0x00ff00ff
  s_cbranch_scc0 L_slow1
  buffer_store_dword v44, v102, s[36:39], s4 offen
L_g1:
  s_mov_b64 exec, -1
  buffer_load_dwordx4 v[80:83], v104, s[36:39], s6 offen sc1
  s_cmp_lt_u32 s26, 5
  s_cselect_b32 s66, 0, 1
  s_branch L_g1n
L_g1s:
  s_bcnt1_i32_b64 s56, vcc
  s_cmp_le_u32 s56, 16
  s_cbranch_scc1 L_g1q
  s_sleep 4
L_g1q:
  s_mov_b64 exec, vcc
  buffer_load_dwordx4 v[80:83], v104, s[36:39], s6 offen sc1
  s_mov_b64 exec, -1
  s_add_u32 s64, s64, 1
  s_cmp_lt_u32 s64, 1048576
  s_cbranch_scc0 L_g1_ok0
L_g1n:
  s_cmp_eq_u32 s66, 0
  s_cbranch_scc0 L_g1w
  ds_read_b32 v36, v110 offset:8
  s_waitcnt lgkmcnt(0)
  v_readfirstlane_b32 s56, v36
  s_nop 0
  s_cmp_eq_u32 s56, 4
  s_cbranch_scc0 L_g1w
  ds_read_b64_tr_b16 v[16:17], v112 offset:0
  ds_read_b64_tr_b16 v[18:19], v112 offset:640
  ds_read_b64_tr_b16 v[20:21], v112 offset:5120
  ds_read_b64_tr_b16 v[22:23], v112 offset:5760
  ds_read_b64_tr_b16 v[24:25], v112 offset:10240
  ds_read_b64_tr_b16 v[26:27], v112 offset:10880
  ds_read_b64_tr_b16 v[28:29], v112 offset:15360
  ds_read_b64_tr_b16 v[30:31], v112 offset:16000
  s_mov_b32 s66, 1
L_g1w:
  s_waitcnt vmcnt(0)
  ds_read_b32 v35, v105
  v_perm_b32 v52, v81, v80, s9
  v_perm_b32 v53, v83, v82, s10
  v_or_b32 v52, v52, v53
  v_cmp_ne_u32 vcc, s27, v52
  s_cbranch_vccnz L_g1s
L_g1_ok0:
  v_and_b32 v44, s18, v80
  v_and_b32 v45, s18, v81
  v_and_b32 v46, s18, v82
  v_and_b32 v47, s18, v83
  s_waitcnt lgkmcnt(0)
  v_cmp_eq_u32 vcc, -1, v35
  s_cbranch_vccz L_g1f
L_g1as:
  ds_read_b32 v35, v105
  s_waitcnt lgkmcnt(0)
  v_cmp_eq_u32 vcc, -1, v35
  s_cbranch_vccz L_g1f
  s_add_u32 s64, s64, 1
  s_cmp_lt_u32 s64, 1048576
  s_cbranch_scc1 L_g1as
L_g1f:
  v_mul_f32 v44, v35, v44
  v_mul_f32 v45, v35, v45
  v_mul_f32 v46, v35, v46
  v_mul_f32 v47, v35, v47
  v_add_f32_dpp v44, v44, v44 row_ror:8 row_mask:0xf bank_mask:0xf
  v_add_f32_dpp v45, v45, v45 row_ror:8 row_mask:0xf bank_mask:0xf
  v_add_f32_dpp v46, v46, v46 row_ror:8 row_mask:0xf bank_mask:0xf
  v_add_f32_dpp v47, v47, v47 row_ror:8 row_mask:0xf bank_mask:0xf
  v_permlane16_swap_b32 v44, v45
  s_nop 0
  v_permlane16_swap_b32 v46, v47
  v_add_f32 v44, v44, v45
  v_add_f32 v46, v46, v47
  s_nop 1
  v_permlane32_swap_b32 v44, v46
  v_add_f32 v44, v44, v46
  v_cvt_pk_bf16_f32 v52, v44, v44
  s_mov_b32 exec_lo, 0x00ff00ff
  s_mov_b32 exec_hi, 0x00ff00ff
  ds_write_b16 v106, v52
  s_mov_b64 exec, -1
  s_branch L_barE
L_hiE:
  s_sub_u32 s56, s26, 12
  s_cmp_lt_u32 s56, 2
  s_cbranch_scc0 L_nohl
  s_mov_b32 s66, 0
  s_mov_b32 s64, 0
  s_mov_b32 s67, s65
  ds_read_b64 v[52:53], v104
L_hl:
  s_buffer_load_dwordx16 s[4:19], s[36:39], s65
  s_buffer_load_dwordx16 s[68:83], s[36:39], s65 offset:64
  s_waitcnt lgkmcnt(0)
  v_writelane_b32 v50, s6, 0
  v_writelane_b32 v50, s10, 1
  v_writelane_b32 v50, s14, 2
  v_writelane_b32 v50, s18, 3
  v_writelane_b32 v50, s70, 4
  v_writelane_b32 v50, s74, 5
  v_writelane_b32 v50, s78, 6
  v_writelane_b32 v50, s82, 7
  v_cmp_ne_u32 vcc, s27, v50
  s_nop 0
  s_and_b64 vcc, vcc, s[22:23]
  s_cbranch_scc0 L_hl_ok
  s_add_u32 s65, s65, 256
  s_add_u32 s66, s66, 1
  s_cmp_lt_u32 s66, 1
  s_cbranch_scc1 L_hl
  v_and_b32 v2, 7, v0
  v_lshlrev_b32 v2, 4, v2
L_hv:
  buffer_load_dwordx4 v[48:51], v2, s[36:39], s67 offen sc1
  s_waitcnt vmcnt(0)
  v_cmp_ne_u32 vcc, s27, v50
  s_nop 0
  s_and_b64 vcc, vcc, s[22:23]
  s_cbranch_scc0 L_hl_f
  s_add_u32 s64, s64, 1
  s_cmp_lt_u32 s64, 1048576
  s_cbranch_scc1 L_hv
  s_branch L_hl_f
L_hl_ok:
  v_writelane_b32 v48, s4, 0
  v_writelane_b32 v48, s8, 1
  v_writelane_b32 v48, s12, 2
  v_writelane_b32 v48, s16, 3
  v_writelane_b32 v48, s68, 4
  v_writelane_b32 v48, s72, 5
  v_writelane_b32 v48, s76, 6
  v_writelane_b32 v48, s80, 7
  v_writelane_b32 v49, s5, 0
  v_writelane_b32 v49, s9, 1
  v_writelane_b32 v49, s13, 2
  v_writelane_b32 v49, s17, 3
  v_writelane_b32 v49, s69, 4
  v_writelane_b32 v49, s73, 5
  v_writelane_b32 v49, s77, 6
  v_writelane_b32 v49, s81, 7
L_hl_f:
  v_cndmask_b32 v62, v48, v52, s[20:21]
  v_cndmask_b32 v63, v49, v53, s[20:21]
  s_nop 0
  v_max_f32_dpp v38, v62, v62 quad_perm:[1,0,3,2] row_mask:0xf bank_mask:0xf
  s_nop 1
  v_max_f32_dpp v38, v38, v38 quad_perm:[2,3,0,1] row_mask:0xf bank_mask:0xf
  s_nop 1
  v_max_f32_dpp v38, v38, v38 row_half_mirror row_mask:0xf bank_mask:0xf
  v_sub_f32 v35, v62, v38
  v_mul_f32 v35, s63, v35
  v_exp_f32 v35, v35
  v_and_b32 v2, 7, v0
  s_and_b32 s56, s26, 1
  s_lshl_b32 s56, s56, 5
  v_lshl_add_u32 v2, v2, 2, s56
  v_mul_f32 v63, v35, v63
  s_nop 1
  v_add_f32_dpp v63, v63, v63 quad_perm:[1,0,3,2] row_mask:0xf bank_mask:0xf
  s_nop 1
  v_add_f32_dpp v63, v63, v63 quad_perm:[2,3,0,1] row_mask:0xf bank_mask:0xf
  s_nop 1
  v_add_f32_dpp v63, v63, v63 row_half_mirror row_mask:0xf bank_mask:0xf
  v_rcp_f32 v64, v63
  s_nop 0
  v_fma_f32 v39, -v63, v64, 1.0
  v_fma_f32 v64, v39, v64, v64
  v_mul_f32 v35, v35, v64
  s_mov_b64 exec, 0xff
  ds_write_b32 v2, v35 offset:53760
  s_mov_b64 exec, -1
L_nohl:
  s_nop 4
  s_waitcnt vmcnt(0)
  s_sub_u32 s56, s26, 8
  s_cmp_lt_u32 s56, 4
  s_cbranch_scc0 L_barE
  v_mov_b32 v2, 54400
  v_mov_b32 v3, 1
  s_mov_b64 exec, 1
  ds_add_u32 v2, v3 offset:8
  s_mov_b64 exec, -1
L_barE:
  s_waitcnt lgkmcnt(0)
  s_barrier
  s_cmp_lt_u32 s26, 5
  s_cbranch_scc0 L_notmm
  s_cmp_eq_u32 s66, 1
  s_cbranch_scc0 L_mmslow
  ds_read_b128 v[40:43], v107 offset:0
  ds_read_b128 v[44:47], v107 offset:64
  ds_read_b128 v[48:51], v107 offset:128
  ds_read_b128 v[52:55], v107 offset:192
  s_waitcnt lgkmcnt(3)
  v_mfma_f32_16x16x32_bf16 v[56:59], v[16:19], v[40:43], v[56:59]
  s_waitcnt lgkmcnt(2)
  v_mfma_f32_16x16x32_bf16 v[56:59], v[20:23], v[44:47], v[56:59]
  s_waitcnt lgkmcnt(1)
  v_mfma_f32_16x16x32_bf16 v[56:59], v[24:27], v[48:51], v[56:59]
  s_waitcnt lgkmcnt(0)
  v_mfma_f32_16x16x32_bf16 v[56:59], v[28:31], v[52:55], v[56:59]
  s_branch L_mmst
L_mmslow:
  ds_read_b64_tr_b16 v[16:17], v112 offset:0
  ds_read_b64_tr_b16 v[18:19], v112 offset:640
  ds_read_b128 v[40:43], v107 offset:0
  ds_read_b64_tr_b16 v[20:21], v112 offset:5120
  ds_read_b64_tr_b16 v[22:23], v112 offset:5760
  ds_read_b128 v[44:47], v107 offset:64
  ds_read_b64_tr_b16 v[24:25], v112 offset:10240
  ds_read_b64_tr_b16 v[26:27], v112 offset:10880
  ds_read_b128 v[48:51], v107 offset:128
  ds_read_b64_tr_b16 v[28:29], v112 offset:15360
  ds_read_b64_tr_b16 v[30:31], v112 offset:16000
  ds_read_b128 v[52:55], v107 offset:192
  s_waitcnt lgkmcnt(9)
  v_mfma_f32_16x16x32_bf16 v[56:59], v[16:19], v[40:43], v[56:59]
  s_waitcnt lgkmcnt(6)
  v_mfma_f32_16x16x32_bf16 v[56:59], v[20:23], v[44:47], v[56:59]
  s_waitcnt lgkmcnt(3)
  v_mfma_f32_16x16x32_bf16 v[56:59], v[24:27], v[48:51], v[56:59]
  s_waitcnt lgkmcnt(0)
  v_mfma_f32_16x16x32_bf16 v[56:59], v[28:31], v[52:55], v[56:59]
L_mmst:
  s_nop 3
  s_mov_b32 exec_lo, 0x00030003
  s_mov_b32 exec_hi, 0x00030003
  s_nop 1
  v_perm_b32 v56, v56, v109, s12
  v_perm_b32 v57, v57, v109, s13
  v_perm_b32 v58, v58, v109, s16
  v_perm_b32 v59, v59, v109, s17
  buffer_store_dwordx4 v[56:59], v108, s[36:39], s8 offen sc1
  s_mov_b64 exec, -1
  s_branch L_exit
L_slow1:
  buffer_store_dword v44, v102, s[36:39], s4 offen sc1
  s_branch L_g1
  s_mov_b64 exec, -1
  s_cmp_eq_u32 s54, 0
  s_cbranch_scc0 L_g1
  v_add_f32_dpp v37, v37, v37 row_ror:8 row_mask:0xf bank_mask:0xf
  v_mov_b32 v39, v37
  s_nop 1
  v_permlane16_swap_b32 v37, v39
  v_add_f32 v37, v37, v39
  v_mov_b32 v39, v37
  s_nop 1
  v_permlane32_swap_b32 v37, v39
  v_add_f32 v37, v37, v39
  v_mov_b32 v60, v38
  v_mov_b32 v61, s27
  v_mov_b32 v62, v37
  v_mov_b32 v63, s27
  s_mov_b64 exec, 1
  buffer_store_dwordx4 v[60:63], off, s[36:39], s5 sc1
  s_mov_b64 exec, -1
  s_branch L_g1
L_notmm:
  s_cmp_eq_u32 s26, 8
  s_cbranch_scc0 L_exit
  s_and_b32 s56, s2, 7
  s_bfe_u32 s57, s2, 0x20006
  s_lshl_b32 s57, s57, 3
  s_add_u32 s57, s57, s56
  s_bitcmp1_b32 s57, 0
  s_cbranch_scc1 L_exit
  s_cmp_lt_u32 s57, 20
  s_cbranch_scc0 L_exit
L_g2s:
  buffer_load_dwordx4 v[64:67], v100, s[36:39], s4 offen offset:0 sc1
  buffer_load_dwordx4 v[68:71], v100, s[36:39], s4 offen offset:2048 sc1
  s_waitcnt vmcnt(0)
  s_mov_b64 exec, -1
  v_perm_b32 v52, v65, v64, s9
  v_perm_b32 v53, v67, v66, s10
  v_sad_u8 v56, v52, s6, 0
  v_sad_u8 v56, v53, s7, v56
  v_perm_b32 v54, v69, v68, s9
  v_perm_b32 v55, v71, v70, s10
  v_sad_u8 v56, v54, s6, v56
  v_sad_u8 v56, v55, s7, v56
  v_cmp_ne_u32 vcc, 0, v56
  s_cbranch_vccz L_g2_ok0
  s_mov_b64 exec, vcc
  s_bcnt1_i32_b64 s56, vcc
  s_cmp_le_u32 s56, 32
  s_cbranch_scc1 L_g2f
  s_sleep 8
  s_add_u32 s64, s64, 1
  s_cmp_lt_u32 s64, 1048576
  s_cbranch_scc1 L_g2s
L_g2f:
  s_mov_b64 exec, vcc
  buffer_load_dwordx4 v[64:67], v100, s[36:39], s4 offen offset:0 sc1
  buffer_load_dwordx4 v[68:71], v100, s[36:39], s4 offen offset:2048 sc1
  s_sleep 2
  buffer_load_dwordx4 v[64:67], v100, s[36:39], s4 offen offset:0 sc1
  buffer_load_dwordx4 v[68:71], v100, s[36:39], s4 offen offset:2048 sc1
  s_sleep 2
  buffer_load_dwordx4 v[64:67], v100, s[36:39], s4 offen offset:0 sc1
  buffer_load_dwordx4 v[68:71], v100, s[36:39], s4 offen offset:2048 sc1
L_g2:
  s_waitcnt vmcnt(4)
  s_mov_b64 exec, -1
  v_perm_b32 v52, v65, v64, s9
  v_perm_b32 v53, v67, v66, s10
  v_sad_u8 v56, v52, s6, 0
  v_sad_u8 v56, v53, s7, v56
  v_perm_b32 v54, v69, v68, s9
  v_perm_b32 v55, v71, v70, s10
  v_sad_u8 v56, v54, s6, v56
  v_sad_u8 v56, v55, s7, v56
  v_cmp_ne_u32 vcc, 0, v56
  s_cbranch_vccz L_g2_ok0
  s_mov_b64 exec, vcc
  buffer_load_dwordx4 v[64:67], v100, s[36:39], s4 offen offset:0 sc1
  buffer_load_dwordx4 v[68:71], v100, s[36:39], s4 offen offset:2048 sc1
  s_sleep 2
  s_add_u32 s64, s64, 1
  s_cmp_lt_u32 s64, 1048576
  s_cbranch_scc1 L_g2
  s_mov_b64 exec, -1
L_g2_ok0:
  v_and_b32 v40, s18, v64
  v_and_b32 v41, s18, v65
  v_and_b32 v42, s18, v66
  v_and_b32 v43, s18, v67
  v_and_b32 v44, s18, v68
  v_and_b32 v45, s18, v69
  v_and_b32 v46, s18, v70
  v_and_b32 v47, s18, v71
L_g2_red:
  v_add_f32 v40, v40, v44
  v_add_f32 v41, v41, v45
  v_add_f32 v42, v42, v46
  v_add_f32 v43, v43, v47
  s_nop 0
  v_permlane32_swap_b32 v40, v42
  v_permlane32_swap_b32 v41, v43
  v_add_f32 v40, v40, v42
  v_add_f32 v41, v41, v43
  s_nop 1
  v_permlane16_swap_b32 v40, v41
  v_add_f32 v40, v40, v41
  s_nop 1
  v_add_f32_dpp v40, v40, v40 row_ror:8 row_mask:0xf bank_mask:0xf
  s_nop 1
  v_add_f32_dpp v40, v40, v40 row_ror:4 row_mask:0xf bank_mask:0xf
  v_cvt_pk_bf16_f32 v40, v40, v40
  v_and_b32 v40, s67, v40
  v_lshlrev_b32 v6, 16, v6
  v_add_f32 v6, v6, v40
  v_cvt_pk_bf16_f32 v6, v6, v6
  s_mov_b32 exec_lo, 0x000f000f
  s_mov_b32 exec_hi, 0x000f000f
  buffer_store_short v6, v101, s[48:51], 0 offen
  s_mov_b64 exec, -1
  s_cmp_eq_u32 s2, 0
  s_cbranch_scc0 L_exit
  v_mov_b32 v2, 0
  v_mov_b32 v3, s27
  s_mov_b64 exec, 1
  buffer_store_dword v3, v2, s[36:39], 0 offen sc1
  s_mov_b64 exec, -1
L_exit:
  s_nop 4
L_end:
  s_nop 4
  s_endpgm
.section .rodata,"a"
.p2align 6
.amdhsa_kernel parallel_sum__mha_block_cached__dense_activation_silu__decode_kernel
  .amdhsa_next_free_vgpr 128
  .amdhsa_next_free_sgpr 102
  .amdhsa_accum_offset 128
  .amdhsa_group_segment_fixed_size 0
  .amdhsa_kernarg_size 88
  .amdhsa_user_sgpr_count 2
  .amdhsa_user_sgpr_kernarg_segment_ptr 1
  .amdhsa_system_sgpr_workgroup_id_x 1
.end_amdhsa_kernel
```
